```python
import torch

def _softmax(x, axis=-1):
    return torch.softmax(x, dim=axis)
def _gelu(x):
    return torch.nn.functional.gelu(x, approximate="tanh")
def _silu(x):
    return torch.nn.functional.silu(x)
def _sigmoid(x):
    return torch.sigmoid(x)
def _layernorm(x, axis=-1, eps=1e-5):
    m = x.mean(dim=axis, keepdim=True)
    v = x.var(dim=axis, keepdim=True, unbiased=False)
    return (x - m) / torch.sqrt(v + eps)
def _scatter_add(tgt, idx, src, axis=0):
    return tgt.clone().index_add_(axis, idx, src)
def _segment_sum(src, seg, n):
    out = torch.zeros((n,) + src.shape[1:], dtype=src.dtype)
    return out.index_add_(0, seg, src)
def _pad(x, pw):
    flat = tuple(v for pair in reversed(pw) for v in pair)
    return torch.nn.functional.pad(x, flat)

kernel_name = 'gated_mix__sliding_block_cached__geglu_ffn__decode'

def setup_inputs():

    _w = (lambda a: (lambda t: t.to(torch.bfloat16) if t.is_floating_point() else t)(torch.as_tensor(a)))
    def _A_setup():
        B, Sq, D = 2, 1, 1024
        Hq, Hkv, Sk, Dh = 32, 4, 32768, 128
        assert Hq % Hkv == 0, (Hq, Hkv)
        return {
            "x": _w((lambda *s: torch.randn(*s, dtype=torch.bfloat16) * 0.05)(B, Sq, D)),
            "k_cache": _w((lambda *s: torch.randn(*s, dtype=torch.bfloat16) * 6.4)(B, Hkv, Sk, Dh)),
            "v_cache": _w((lambda *s: torch.randn(*s, dtype=torch.bfloat16) * 0.4)(B, Hkv, Sk, Dh)),
            "wq": _w((lambda *s: torch.randn(*s, dtype=torch.bfloat16) * 6.4)(D, Hq * Dh) * (D ** -0.5)),
            "wo": _w((lambda *s: torch.randn(*s, dtype=torch.bfloat16) * 0.4)(Hq * Dh, D) * ((Hq * Dh) ** -0.5)),
        }
    _A_in = _A_setup()

    def _B_setup():
        B, S, D, F = 2, 1, 1024, 3584
        return {
            "x": _w((lambda *s: torch.randn(*s, dtype=torch.bfloat16) * 0.05)(B, S, D)),
            "w_gate": _w((lambda *s: torch.randn(*s, dtype=torch.bfloat16) * 0.05)(D, F)),
            "w_up": _w((lambda *s: torch.randn(*s, dtype=torch.bfloat16) * 0.05)(D, F)),
            "w_down": _w((lambda *s: torch.randn(*s, dtype=torch.bfloat16) * 0.05)(F, D)),
        }
    _B_in = _B_setup()

    return {
        "A_x": _A_in["x"],
        "A_k_cache": _A_in["k_cache"],
        "A_v_cache": _A_in["v_cache"],
        "A_wq": _A_in["wq"],
        "A_wo": _A_in["wo"],
        "B_x": _B_in["x"],
        "B_w_gate": _B_in["w_gate"],
        "B_w_up": _B_in["w_up"],
        "B_w_down": _B_in["w_down"],
        "gate_w": _w((lambda *s: torch.randn(*s, dtype=torch.bfloat16) * 0.05)(1024) * 16.0),
    }

def reference(A_x, A_k_cache, A_v_cache, A_wq, A_wo, B_x, B_w_gate, B_w_up, B_w_down, gate_w):
    def _A_ref(x, k_cache, v_cache, wq, wo):
        B, Sq, D = x.shape
        Hq, Dh = 32, 128
        Hkv, Sk = k_cache.shape[1], k_cache.shape[2]
        W = min(4096, max(256, Sk // 4))
        rep = Hq // Hkv
        q = (lambda x, *d: x.permute(*d))((x @ wq).reshape(B, Sq, Hq, Dh), 0, 2, 1, 3)
        k = (lambda x, n, axis: torch.repeat_interleave(x, n, dim=axis))(k_cache[:, :, Sk - W:, :], rep, axis=1)
        v = (lambda x, n, axis: torch.repeat_interleave(x, n, dim=axis))(v_cache[:, :, Sk - W:, :], rep, axis=1)
        scores = torch.einsum("bhqd,bhkd->bhqk", q, k) * (Dh ** -0.5)
        p = _softmax(scores, axis=-1)
        o = torch.einsum("bhqk,bhkd->bhqd", p, v)
        return (lambda x, *d: x.permute(*d))(o, 0, 2, 1, 3).reshape(B, Sq, Hq * Dh) @ wo

    def _B_ref(x, w_gate, w_up, w_down):
        return (_gelu(x @ w_gate) * (x @ w_up)) @ w_down

    x = A_x
    g = _sigmoid((x * gate_w).sum(-1, keepdims=True))
    a = _A_ref(x, A_k_cache, A_v_cache, A_wq, A_wo)
    b = _B_ref(x, B_w_gate, B_w_up, B_w_down)
    return g * a + (1 - g) * b
```

```asm
; @launch grid=(256,1,1) block=(576,1,1) lds=151552
.amdgcn_target "amdgcn-amd-amdhsa--gfx950"
.text
.globl gated_mix__sliding_block_cached__geglu_ffn__decode_kernel
.p2align 8
.type gated_mix__sliding_block_cached__geglu_ffn__decode_kernel,@function
gated_mix__sliding_block_cached__geglu_ffn__decode_kernel:
  s_cmp_ge_u32 s2, 256
  s_cbranch_scc1 L_end
  s_load_dwordx2 s[32:33], s[0:1], 24
  s_load_dwordx16 s[4:19], s[0:1], 0
  s_load_dwordx8 s[20:27], s[0:1], 64
  s_load_dwordx2 s[28:29], s[0:1], 96
  v_lshrrev_b32 v1, 6, v0
  v_lshrrev_b32 v34, 3, v0
  v_readfirstlane_b32 s3, v1
  v_and_b32 v35, 7, v0
  v_and_b32 v36, 2, v34
  s_mov_b32 s30, 0x100000
  s_mov_b32 s35, 0x20000
  s_and_b32 s95, s2, 7
  s_lshl_b32 s94, s95, 2
  s_lshl_b32 s95, s95, 3
  s_mov_b32 s100, 0xa9802a00
  s_mov_b32 s101, 0xf9d17b54
  s_lshr_b32 s94, 0x98b98766, s94
  s_lshr_b64 s[100:101], s[100:101], s95
  s_and_b32 s94, s94, 15
  s_and_b32 s95, s100, 31
  s_sub_u32 s94, s94, 8
  s_bfe_u32 s93, s100, 0x10007
  s_lshr_b32 s101, s2, 3
  s_bfe_u32 s100, s100, 0x20005
  s_lshl1_add_u32 s101, s101, s93
  s_cmp_lg_u32 s3, 0
  s_cbranch_scc1 L_worker
  s_setprio 3
  v_xor_b32 v35, v35, v36
  v_lshlrev_b32 v35, 4, v35
  v_xor_b32 v36, 64, v35
  v_lshl_add_u32 v10, v34, 13, v35
  v_lshl_add_u32 v11, v34, 13, v36
  v_add_u32 v11, 64512, v11
  v_add_u32 v12, 129024, v10
  v_add_u32 v13, 129024, v11
  s_lshl_b32 s68, s101, 7
  s_lshl_b32 s60, s95, 18
  s_add_u32 s60, s60, s68
  s_mov_b32 s34, 8388608
  s_lshl_b32 s93, s94, 12
  s_add_u32 m0, s93, 20480
  s_add_u32 s93, m0, 20480
  s_min_u32 s93, s93, 53248
  s_waitcnt lgkmcnt(0)
L_ld0:
  buffer_load_dwordx4 v10, s[32:35], s60 offen nt lds
  buffer_load_dwordx4 v11, s[32:35], s60 offen offset:1024 nt lds
  buffer_load_dwordx4 v12, s[32:35], s60 offen offset:2048 nt lds
  buffer_load_dwordx4 v13, s[32:35], s60 offen offset:3072 nt lds
  s_add_u32 s60, s60, 262144
  s_add_u32 m0, m0, 4096
  s_cmp_lg_u32 m0, s93
  s_cbranch_scc1 L_ld0
  s_load_dwordx2 s[80:81], s[28:29], 192512
  v_lshrrev_b32 v4, 4, v0
  v_and_b32 v5, 15, v0
  v_xor_b32 v6, v5, v4
  v_lshlrev_b32 v6, 4, v6
  v_lshl_add_u32 v18, v4, 8, v6
  v_xor_b32 v19, 64, v18
  v_xor_b32 v20, 128, v18
  v_xor_b32 v21, 192, v18
  v_lshlrev_b32 v6, 1, v4
  v_xor_b32 v6, v5, v6
  v_lshlrev_b32 v6, 4, v6
  v_lshl_add_u32 v22, v4, 8, v6
  v_xor_b32 v23, 128, v22
  v_lshl_add_u32 v24, v4, 11, v6
  v_add_u32 v25, 7168, v24
  v_xor_b32 v27, 128, v24
  v_add_u32 v26, 14336, v27
  v_add_u32 v27, 21504, v27
  v_mul_u32_u24 v7, 7168, v34
  v_add_u32 v14, v7, v35
  v_add_u32 v15, v7, v36
  v_add_u32 v15, 56320, v15
  v_add_u32 v16, 112640, v14
  v_add_u32 v17, 112640, v15
  s_min_i32 s94, s94, 3
  v_mov_b32 v28, s94
  v_lshlrev_b32 v29, 2, v0
  s_and_b32 s67, s2, 7
  s_lshl_b32 s67, s67, 5
  s_lshr_b32 s68, s2, 3
  s_add_u32 s67, s67, s68
  s_mul_i32 s69, s67, 7
  s_lshr_b32 s63, s69, 5
  s_lshl_b32 s63, s63, 7
  s_and_b32 s69, s69, 31
  s_mul_i32 s69, s69, 229376
  s_add_u32 s63, s63, s69
  s_mov_b32 s64, s63
  s_and_b32 s69, s68, 7
  s_xor_b32 s69, s69, 0
  s_lshl_b32 s69, s69, 8
  s_lshr_b32 s67, s67, 3
  s_mul_i32 s66, s67, 229376
  s_add_u32 s66, s66, s69
  s_and_b32 s65, s2, 3
  s_lshl_b32 s65, s65, 3
  s_and_b32 s67, s2, 4
  s_add_u32 s65, s65, s67
  s_lshr_b32 s67, s2, 6
  s_add_u32 s65, s65, s67
  s_lshl_b32 s65, s65, 18
  s_add_u32 s65, s65, s69
  s_and_b32 s69, s2, 7
  s_xor_b32 s69, s69, 0
  s_lshl_b32 s69, s69, 8
  s_mul_i32 s66, s68, 229376
  s_add_u32 s66, s66, s69
  s_lshl_b32 s65, s68, 18
  s_add_u32 s65, s65, s69
  s_and_b32 s67, s2, 7
  s_lshl_b32 s67, s67, 5
  s_lshr_b32 s70, s2, 3
  s_add_u32 s67, s67, s70
  s_and_b32 s70, s67, -2
  s_mul_i32 s70, s70, 7
  s_lshr_b32 s63, s70, 5
  s_lshl_b32 s63, s63, 7
  s_and_b32 s70, s70, 31
  s_mul_i32 s70, s70, 229376
  s_add_u32 s63, s63, s70
  v_mov_b32 v44, 1
  s_lshr_b32 s76, s2, 6
  s_lshr_b32 s77, s2, 3
  s_add_u32 s75, s76, s77
  s_and_b32 s75, s75, 7
  s_and_b32 s77, s2, 7
  s_mov_b32 s78, s69
  s_mul_i32 s77, s77, 8
  s_add_u32 s77, s77, s75
  s_lshl_b32 s77, s77, 7
  s_add_u32 s77, s77, 229376
  v_mov_b32 v46, s77
  s_mul_i32 s75, s75, 32
  s_mul_i32 s76, s76, 4
  s_add_u32 s76, s76, s75
  s_lshl_b32 s65, s76, 15
  s_add_u32 s65, s65, s78
  s_add_u32 s75, s75, 16
  s_lshl_b32 s75, s75, 15
  s_add_u32 s78, s78, s75
  s_and_b32 s67, s2, 7
  s_lshl_b32 s61, s67, 23
  s_lshl_b32 s69, s68, 15
  s_add_u32 s61, s61, s69
  s_add_u32 s61, s61, 7340032
  s_mov_b32 s62, s61
  s_mov_b64 s[36:37], s[6:7]
  s_mov_b32 s38, 67108864
  s_mov_b32 s39, 0x20000
  s_mov_b64 s[40:41], s[8:9]
  s_mov_b32 s42, 67108864
  s_mov_b32 s43, 0x20000
  s_bitcmp1_b32 s2, 3
  s_cselect_b64 s[44:45], s[18:19], s[16:17]
  s_mov_b32 s46, 7340032
  s_mov_b32 s47, 0x20000
  s_mov_b64 s[52:53], s[12:13]
  s_mov_b32 s54, 8388608
  s_mov_b32 s55, 0x20000
  s_mov_b64 s[56:57], s[20:21]
  s_mov_b32 s58, 7340032
  s_mov_b32 s59, 0x20000
  s_barrier
  s_cmp_eq_u32 m0, 53248
  s_cbranch_scc1 L_qxd
L_ld_1:
  buffer_load_dwordx4 v10, s[32:35], s60 offen nt lds
  buffer_load_dwordx4 v11, s[32:35], s60 offen offset:1024 nt lds
  buffer_load_dwordx4 v12, s[32:35], s60 offen offset:2048 nt lds
  buffer_load_dwordx4 v13, s[32:35], s60 offen offset:3072 nt lds
  s_add_u32 s60, s60, 262144
  s_add_u32 m0, m0, 4096
  s_waitcnt vmcnt(20)
  v_add_u32 v28, 1, v28
  ds_max_i32 v29, v28
  s_cmp_lg_u32 m0, 53248
  s_cbranch_scc1 L_ld_1
L_qxd:
  s_bfe_u32 s67, s2, 0x30003
  s_lshl_b32 s67, s67, 12
  s_mov_b32 s68, s67
L_rt_2:
  s_add_u32 m0, s68, 114688
  s_add_u32 s69, s68, s61
  buffer_load_dwordx4 v18, s[36:39], s69 offen nt lds
  buffer_load_dwordx4 v19, s[36:39], s69 offen offset:1024 nt lds
  buffer_load_dwordx4 v20, s[36:39], s69 offen offset:2048 nt lds
  buffer_load_dwordx4 v21, s[36:39], s69 offen offset:3072 nt lds
  s_add_u32 s68, s68, 4096
  s_and_b32 s68, s68, 0x7fff
  s_waitcnt vmcnt(20)
  v_add_u32 v28, 1, v28
  ds_max_i32 v29, v28
  s_cmp_lg_u32 s68, s67
  s_cbranch_scc1 L_rt_2
L_rt_3:
  s_add_u32 m0, s68, 53248
  s_add_u32 s69, s68, s61
  buffer_load_dwordx4 v22, s[40:43], s69 offen nt lds
  buffer_load_dwordx4 v22, s[40:43], s69 offen offset:1024 nt lds
  buffer_load_dwordx4 v23, s[40:43], s69 offen offset:2048 nt lds
  buffer_load_dwordx4 v23, s[40:43], s69 offen offset:3072 nt lds
  s_add_u32 s68, s68, 4096
  s_and_b32 s68, s68, 0x7fff
  s_waitcnt vmcnt(20)
  v_add_u32 v28, 1, v28
  ds_max_i32 v29, v28
  s_cmp_lg_u32 s68, s67
  s_cbranch_scc1 L_rt_3
  s_mov_b64 exec, 1
  global_load_dwordx2 v[50:51], v46, s[28:29] sc1
  s_mov_b64 exec, -1
  s_waitcnt lgkmcnt(0)
  s_add_u32 s80, s80, 1
  s_addc_u32 s81, s81, 0
  s_lshl_b32 s79, s80, 8
  s_lshr_b64 s[80:81], s[80:81], 24
  v_not_b32 v49, s79
  s_mov_b32 m0, 86016
  v_mov_b32 v31, 272
L_ld_4:
  buffer_load_dwordx4 v14, s[44:47], s63 offen nt lds
  buffer_load_dwordx4 v15, s[44:47], s63 offen offset:1024 nt lds
  buffer_load_dwordx4 v16, s[44:47], s63 offen offset:2048 nt lds
  buffer_load_dwordx4 v17, s[44:47], s63 offen offset:3072 nt lds
  ds_read_b32 v30, v31
  s_add_u32 s63, s63, 229376
  s_cmp_ge_u32 s63, 7340032
  s_cselect_b32 s73, 7339904, 0
  s_sub_u32 s63, s63, s73
  s_add_u32 m0, m0, 4096
  s_waitcnt vmcnt(20)
  v_add_u32 v28, 1, v28
  ds_max_i32 v29, v28
  s_cmp_lg_u32 m0, 114688
  s_cbranch_scc1 L_ld_4
  s_waitcnt lgkmcnt(0)
  v_readfirstlane_b32 s74, v30
  s_cmp_ge_u32 s74, 4
  s_cbranch_scc1 L_fok_5
  s_waitcnt vmcnt(0)
  v_add_u32 v32, 5, v28
  ds_max_i32 v29, v32
L_fsp_6:
  ds_read_b32 v30, v31
  s_waitcnt lgkmcnt(0)
  v_readfirstlane_b32 s74, v30
  s_sub_u32 s30, s30, 1
  s_cbranch_scc1 L_end
  s_cmp_lt_u32 s74, 4
  s_cbranch_scc1 L_fsp_6
L_fok_5:
L_cv:
  v_readfirstlane_b32 s75, v50
  v_readfirstlane_b32 s76, v51
  s_xor_b32 s75, s75, s79
  s_lshr_b32 s75, s75, 8
  s_xor_b32 s76, s76, s80
  s_or_b32 s75, s75, s76
  s_cbranch_scc0 L_cok
  s_mov_b64 exec, 1
  global_load_dwordx2 v[50:51], v46, s[28:29] sc1
  s_mov_b64 exec, -1
  s_waitcnt vmcnt(0)
  s_sub_u32 s30, s30, 16
  s_cbranch_scc0 L_cv
  s_endpgm
L_cok:
  s_mov_b32 m0, 20480
  v_mov_b32 v31, 276
L_ld_10:
  buffer_load_dwordx4 v14, s[44:47], s63 offen nt lds
  buffer_load_dwordx4 v15, s[44:47], s63 offen offset:1024 nt lds
  buffer_load_dwordx4 v16, s[44:47], s63 offen offset:2048 nt lds
  buffer_load_dwordx4 v17, s[44:47], s63 offen offset:3072 nt lds
  ds_read_b32 v30, v31
  s_add_u32 s63, s63, 229376
  s_cmp_ge_u32 s63, 7340032
  s_cselect_b32 s73, 7339904, 0
  s_sub_u32 s63, s63, s73
  s_add_u32 m0, m0, 4096
  s_waitcnt vmcnt(20)
  v_add_u32 v28, 1, v28
  ds_max_i32 v29, v28
  s_cmp_lg_u32 m0, 49152
  s_cbranch_scc1 L_ld_10
  s_waitcnt lgkmcnt(0)
  v_readfirstlane_b32 s74, v30
  s_cmp_ge_u32 s74, 4
  s_cbranch_scc1 L_fok_11
  s_waitcnt vmcnt(0)
  v_add_u32 v32, 5, v28
  ds_max_i32 v29, v32
L_fsp_12:
  ds_read_b32 v30, v31
  s_waitcnt lgkmcnt(0)
  v_readfirstlane_b32 s74, v30
  s_sub_u32 s30, s30, 1
  s_cbranch_scc1 L_end
  s_cmp_lt_u32 s74, 4
  s_cbranch_scc1 L_fsp_12
L_fok_11:
  s_mov_b64 s[86:87], 1
  s_mov_b32 m0, 114688
L_ld_15:
  s_nop 0
  buffer_load_dwordx4 v24, s[56:59], s66 offen nt lds
  buffer_load_dwordx4 v25, s[56:59], s66 offen offset:1024 nt lds
  buffer_load_dwordx4 v26, s[56:59], s66 offen offset:2048 nt lds
  buffer_load_dwordx4 v27, s[56:59], s66 offen offset:3072 nt lds
  s_add_u32 s66, s66, 32768
  s_add_u32 m0, m0, 4096
  s_waitcnt vmcnt(20)
  v_add_u32 v28, 1, v28
  ds_max_i32 v29, v28
  s_cmp_lg_u32 m0, 139264
  s_cbranch_scc1 L_ld_15
  v_mov_b32 v31, 280
L_c0:
  s_mov_b64 exec, s[86:87]
  global_atomic_add v49, v46, v44, s[28:29] sc0 sc1
  s_mov_b64 exec, -1
  buffer_load_dwordx4 v24, s[56:59], s66 offen nt lds
  buffer_load_dwordx4 v25, s[56:59], s66 offen offset:1024 nt lds
  buffer_load_dwordx4 v26, s[56:59], s66 offen offset:2048 nt lds
  buffer_load_dwordx4 v27, s[56:59], s66 offen offset:3072 nt lds
  ds_read_b32 v30, v31
  s_lshl_b32 s86, s86, 1
  s_add_u32 s66, s66, 32768
  s_add_u32 m0, m0, 4096
  s_waitcnt vmcnt(20)
  v_add_u32 v28, 1, v28
  ds_max_i32 v29, v28
  s_cmp_lg_u32 m0, 143360
  s_cbranch_scc1 L_c0
  s_waitcnt lgkmcnt(0)
  v_readfirstlane_b32 s74, v30
  s_cmp_ge_u32 s74, 8
  s_cbranch_scc1 L_fok_16
  s_waitcnt vmcnt(0)
  v_add_u32 v32, 5, v28
  ds_max_i32 v29, v32
L_fsp_17:
  ds_read_b32 v30, v31
  s_waitcnt lgkmcnt(0)
  v_readfirstlane_b32 s74, v30
  s_sub_u32 s30, s30, 1
  s_cbranch_scc1 L_end
  s_cmp_lt_u32 s74, 8
  s_cbranch_scc1 L_fsp_17
L_fok_16:
  s_mov_b32 m0, 53248
L_c2:
  s_mov_b64 exec, s[86:87]
  global_atomic_add v49, v46, v44, s[28:29] sc0 sc1
  s_mov_b64 exec, -1
  buffer_load_dwordx4 v24, s[52:55], s65 offen nt lds
  buffer_load_dwordx4 v25, s[52:55], s65 offen offset:1024 nt lds
  buffer_load_dwordx4 v26, s[52:55], s65 offen offset:2048 nt lds
  buffer_load_dwordx4 v27, s[52:55], s65 offen offset:3072 nt lds
  s_lshl_b32 s86, s86, 1
  s_add_u32 s65, s65, 32768
  s_add_u32 m0, m0, 4096
  s_waitcnt vmcnt(20)
  v_add_u32 v28, 1, v28
  ds_max_i32 v29, v28
  s_cmp_lg_u32 m0, 69632
  s_cbranch_scc1 L_c2
  s_mov_b32 s76, 0
L_d2:
  v_readlane_b32 s75, v49, s76
  s_sub_u32 s75, s75, s79
  s_cmp_ge_u32 s75, 16
  s_cbranch_scc1 L_x2
  s_mul_i32 s75, s75, 32768
  s_add_u32 s75, s75, s78
  s_and_b32 s86, s86, 127
  s_cbranch_scc0 L_n2
  s_mov_b64 exec, s[86:87]
  global_atomic_add v49, v46, v44, s[28:29] sc0 sc1
  s_mov_b64 exec, -1
  s_lshl_b32 s86, s86, 1
L_n2:
  buffer_load_dwordx4 v24, s[52:55], s75 offen nt lds
  buffer_load_dwordx4 v25, s[52:55], s75 offen offset:1024 nt lds
  buffer_load_dwordx4 v26, s[52:55], s75 offen offset:2048 nt lds
  buffer_load_dwordx4 v27, s[52:55], s75 offen offset:3072 nt lds
  s_add_u32 m0, m0, 4096
  s_add_u32 s76, s76, 1
  s_cmp_eq_u32 s76, 7
  s_waitcnt vmcnt(20)
  s_cbranch_scc1 L_f2
  v_add_u32 v28, 1, v28
  ds_max_i32 v29, v28
  s_branch L_d2
L_x2:
  s_cmp_lt_u32 s75, 256
  s_cbranch_scc1 L_e2
  s_waitcnt vmcnt(0)
  s_sub_u32 s30, s30, 16
  s_cbranch_scc0 L_d2
  s_endpgm
L_f2:
  v_add_u32 v28, 1, v28
L_e2:
  v_writelane_b32 v49, s76, 7
  s_sub_u32 s76, 7, s76
  s_mov_b64 exec, 255
  ds_write_b32 v29, v49 offset:352
  s_mov_b64 exec, 1
  v_add_u32 v28, s76, v28
  s_mov_b64 exec, -1
  ds_max_i32 v29, v28
  s_waitcnt vmcnt(16)
  v_add_u32 v28, 1, v28
  ds_max_i32 v29, v28
  s_waitcnt vmcnt(12)
  v_add_u32 v28, 1, v28
  ds_max_i32 v29, v28
  s_waitcnt vmcnt(8)
  v_add_u32 v28, 1, v28
  ds_max_i32 v29, v28
  s_waitcnt vmcnt(4)
  v_add_u32 v28, 1, v28
  ds_max_i32 v29, v28
  s_waitcnt vmcnt(0)
  v_add_u32 v28, 1, v28
  ds_max_i32 v29, v28
  s_endpgm
L_worker:
  s_nop 0
  s_nop 0
L_nopf:
  v_and_b32 v0, 63, v0
  v_mov_b32 v4, 0
  v_mov_b32 v5, 0
  v_mov_b32 v6, 0
  v_mov_b32 v7, 0
  v_lshlrev_b32 v2, 4, v0
  ds_write_b128 v2, v[4:7]
  ds_write_b128 v2, v[4:7] offset:1024
  v_mov_b32 v8, -8
  ds_write_b32 v4, v8 offset:0
  s_lshl_b32 s55, s95, 6
  v_lshrrev_b32 v2, 4, v0
  v_and_b32 v9, 1, v0
  v_lshlrev_b32 v9, 11, v9
  v_lshl_add_u32 v9, v2, 4, v9
  s_mov_b32 s34, 4096
  s_mov_b32 s62, 0x000f000f
  s_mov_b32 s63, 0x000f000f
  s_waitcnt lgkmcnt(0)
  s_load_dwordx2 s[48:49], s[28:29], 192512
  s_add_u32 s55, s55, 147456
  v_add_u32 v34, s55, v9
  s_mov_b64 s[32:33], s[4:5]
  s_cmp_gt_u32 s3, 4
  s_cbranch_scc1 L_nox1
  s_lshl_b32 s55, s3, 10
  s_add_u32 m0, s55, 146432
  s_sub_u32 s55, s55, 1024
  v_lshlrev_b32 v5, 4, v0
  buffer_load_dwordx4 v5, s[32:35], s55 offen lds
L_nox1:
  s_barrier
  s_sub_u32 s54, s3, 1
  s_and_b32 s54, s54, 3
  s_mov_b32 s31, -8
  v_and_b32 v1, 15, v0
  v_mov_b32 v3, 0
  v_mov_b32 v4, 0xfffff000
  v_mov_b32 v33, 1
  s_mov_b32 s38, 2359296
  s_mov_b32 s39, 0x20000
  s_add_u32 s36, s28, 0
  s_addc_u32 s37, s29, 0
  v_bfe_u32 v5, v0, 2, 2
  v_lshl_add_u32 v5, v2, 3, v5
  v_and_b32 v6, 3, v0
  v_lshlrev_b32 v6, 3, v6
  v_bfe_u32 v7, v0, 3, 2
  v_xor_b32 v7, s54, v7
  v_lshl_add_u32 v7, v7, 5, v6
  v_lshl_add_u32 v10, v5, 7, v7
  s_lshl_b32 s55, s54, 1
  v_bfe_u32 v7, v0, 2, 3
  v_xor_b32 v7, s55, v7
  v_lshl_add_u32 v7, v7, 5, v6
  v_lshl_add_u32 v24, v5, 8, v7
  s_mov_b32 s60, 0x00030003
  s_mov_b32 s61, 0x00030003
  s_waitcnt lgkmcnt(0)
  s_add_u32 s48, s48, 1
  s_addc_u32 s49, s49, 0
  s_and_b32 s50, s48, 4095
  s_lshr_b32 s55, s48, 12
  s_add_u32 s55, s55, s48
  s_and_b32 s51, s55, 4095
  s_lshr_b64 s[56:57], s[48:49], 24
  s_add_u32 s55, s56, s48
  s_and_b32 s52, s55, 4095
  s_lshr_b32 s55, s49, 4
  s_add_u32 s55, s55, s48
  s_and_b32 s53, s55, 4095
  s_getreg_b32 s55, hwreg(HW_REG_XCC_ID, 0, 4)
  s_lshl4_add_u32 s71, s48, s55
  s_cmp_gt_u32 s3, 4
  s_cbranch_scc1 L_F
  v_add_u32 v10, 20480, v10
  s_lshr_b32 s55, s101, 2
  s_lshl_b32 s55, s55, 12
  s_lshl_b32 s56, s100, 10
  s_add_u32 s55, s55, s56
  s_and_b32 s56, s101, 3
  s_lshl_b32 s56, s56, 8
  s_add_u32 s55, s55, s56
  s_lshl_b32 s56, s54, 6
  s_add_u32 s55, s55, s56
  v_and_b32 v5, 1, v0
  v_lshlrev_b32 v5, 16, v5
  v_lshl_add_u32 v5, v2, 4, v5
  v_add_u32 v11, s55, v5
  s_lshl_b32 s55, s94, 12
  v_add_u32 v10, s55, v10
  v_mov_b32 v104, 0
  v_mov_b32 v105, 0
  v_mov_b32 v106, 0
  v_mov_b32 v107, 0
  s_waitcnt vmcnt(0)
  s_mov_b64 exec, 1
  ds_add_u32 v3, v33 offset:292
  s_mov_b64 exec, -1
L_csp_18:
  ds_read_b32 v5, v3 offset:292
  s_waitcnt lgkmcnt(0)
  v_readfirstlane_b32 s55, v5
  s_sub_u32 s30, s30, 1
  s_cbranch_scc1 L_end
  s_cmp_lt_u32 s55, 4
  s_cbranch_scc1 L_csp_18
L_qx:
  ds_read_b128 v[40:43], v34
  ds_read_b128 v[44:47], v34 offset:64
  s_add_u32 s94, s94, 1
  s_cmp_ge_i32 s31, s94
  s_cbranch_scc1 L_pok_19
L_psp_20:
  ds_read_b32 v5, v3 offset:0
  s_waitcnt lgkmcnt(0)
  v_readfirstlane_b32 s31, v5
  s_sub_u32 s30, s30, 1
  s_cbranch_scc1 L_end
  s_cmp_lt_i32 s31, s94
  s_cbranch_scc1 L_psp_20
L_pok_19:
  ds_read_b64_tr_b16 v[72:73], v10
  ds_read_b64_tr_b16 v[74:75], v10 offset:512
  s_min_i32 s55, s31, 8
  s_cmp_gt_i32 s55, s94
  s_cbranch_scc0 L_qx1
  ds_read_b64_tr_b16 v[76:77], v10 offset:4096
  ds_read_b64_tr_b16 v[78:79], v10 offset:4608
  s_add_u32 s94, s94, 1
  v_add_u32 v10, 4096, v10
  v_add_u32 v34, 64, v34
  s_waitcnt lgkmcnt(0)
  v_mfma_f32_16x16x32_bf16 v[104:107], v[76:79], v[44:47], v[104:107]
L_qx1:
  v_add_u32 v10, 4096, v10
  v_add_u32 v34, 64, v34
  s_cmp_lt_i32 s94, 8
  s_waitcnt lgkmcnt(0)
  v_mfma_f32_16x16x32_bf16 v[104:107], v[72:75], v[40:43], v[104:107]
  s_cbranch_scc1 L_qx
  s_mov_b64 exec, 1
  ds_add_u32 v3, v33 offset:272
  s_mov_b64 exec, -1
  s_nop 3
  v_and_or_b32 v108, v104, v4, s50
  v_and_or_b32 v109, v105, v4, s51
  v_and_or_b32 v110, v106, v4, s52
  v_and_or_b32 v111, v107, v4, s53
  s_mov_b64 exec, s[60:61]
  buffer_store_dwordx4 v[108:111], v11, s[36:39], 0 offen sc1
  s_mov_b64 exec, -1
  s_mov_b32 s64, 0xff00ff00
  s_mov_b32 s65, 0xff00ff00
  s_mov_b32 s66, 0xcccccccc
  s_mov_b32 s67, 0xcccccccc
  s_mov_b64 s[44:45], s[24:25]
  s_mov_b32 s46, 4096
  s_mov_b32 s47, 0x20000
  s_and_b32 s68, s2, 7
  s_lshl_b32 s68, s68, 5
  s_lshr_b32 s55, s2, 3
  s_add_u32 s68, s68, s55
  v_add_u32 v140, 53248, v24
  v_xor_b32 v141, 32, v140
  v_and_b32 v5, 1, v0
  v_mul_u32_u24 v6, 448, v5
  v_lshl_add_u32 v6, v2, 4, v6
  v_add_u32 v153, 10240, v6
  v_lshlrev_b32 v155, 3, v5
  s_lshl_b32 s55, s54, 8
  s_add_u32 s55, s55, 8192
  v_and_b32 v6, 3, v0
  v_lshlrev_b32 v6, 6, v6
  v_lshl_add_u32 v6, v2, 4, v6
  v_add_u32 v154, s55, v6
  v_lshlrev_b32 v156, 4, v0
  s_and_b32 s55, s2, 7
  s_lshl_b32 s55, s55, 15
  s_lshr_b32 s56, s2, 3
  s_lshl_b32 s56, s56, 7
  s_add_u32 s55, s55, s56
  s_add_u32 s55, s55, 2097152
  v_lshrrev_b32 v5, 3, v0
  v_lshlrev_b32 v5, 12, v5
  v_and_b32 v6, 7, v0
  v_lshl_add_u32 v5, v6, 4, v5
  v_add_u32 v157, s55, v5
  s_and_b32 s73, s2, 7
  s_lshr_b32 s75, s2, 3
  s_mov_b32 s76, 0x3fb8aa3b
  s_lshl_b32 s55, s54, 13
  s_add_u32 s55, s55, 114688
  v_xor_b32 v5, v2, v1
  v_lshlrev_b32 v5, 4, v5
  v_lshl_add_u32 v5, v1, 8, v5
  v_add_u32 v15, s55, v5
  v_xor_b32 v16, 64, v15
  v_xor_b32 v17, 128, v15
  v_xor_b32 v18, 192, v15
  v_add_u32 v24, 53248, v24
  v_xor_b32 v25, 32, v24
  s_lshl_b32 s55, s73, 2
  s_add_u32 s55, s55, s54
  s_lshl_b32 s55, s55, 12
  v_lshlrev_b32 v5, 4, v0
  v_add_u32 v12, s55, v5
  s_mul_i32 s55, s54, 576
  s_add_u32 s55, s55, 2048
  v_lshrrev_b32 v5, 5, v0
  v_mul_u32_u24 v5, 288, v5
  v_and_b32 v6, 31, v0
  v_lshl_add_u32 v5, v6, 3, v5
  v_add_u32 v13, s55, v5
  v_and_b32 v6, 7, v0
  v_mul_u32_u24 v7, 288, v6
  v_lshl_add_u32 v8, v2, 4, v7
  v_add_u32 v14, 2048, v8
  v_add_u32 v8, 4352, v8
  v_mov_b32 v9, 512
  v_cndmask_b32 v21, v8, v9, s[64:65]
  v_cndmask_b32 v22, v9, v8, s[64:65]
  v_lshlrev_b32 v9, 4, v6
  v_add_u32 v23, 6656, v9
  s_lshl_b32 s55, s54, 2
  v_add_u32 v20, s55, v23
  s_lshl_b32 s55, s54, 6
  s_add_u32 s55, s55, 4352
  v_and_b32 v9, 8, v0
  v_lshlrev_b32 v9, 2, v9
  v_lshl_add_u32 v9, v2, 3, v9
  v_add3_u32 v19, v7, v9, s55
  s_lshl_b32 s55, s73, 17
  s_lshl_b32 s56, s54, 12
  s_add_u32 s55, s55, s56
  s_lshl_b32 s56, s75, 7
  s_add_u32 s55, s55, s56
  s_add_u32 s55, s55, 1048576
  v_lshlrev_b32 v9, 1, v9
  v_lshl_add_u32 v9, v6, 14, v9
  v_add_u32 v26, s55, v9
  s_lshl_b32 s55, s73, 12
  s_lshl_b32 s56, s75, 4
  s_add_u32 s55, s55, s56
  s_add_u32 s55, s55, 131072
  v_lshlrev_b32 v9, 9, v6
  v_add_u32 v27, s55, v9
  s_lshl_b32 s55, s68, 12
  s_and_b32 s58, s54, 1
  s_lshl_b32 s59, s58, 6
  s_add_u32 s55, s55, s59
  s_add_u32 s55, s55, 1048576
  v_lshrrev_b32 v5, 2, v0
  v_and_b32 v6, 3, v0
  v_lshlrev_b32 v7, 4, v6
  v_lshl_add_u32 v8, v5, 7, v7
  v_add_u32 v28, s55, v8
  s_lshr_b32 s57, s68, 2
  s_lshl_b32 s57, s57, 9
  s_add_u32 s57, s57, 131072
  v_and_b32 v8, 1, v0
  v_lshlrev_b32 v8, 8, v8
  v_lshl_add_u32 v8, v5, 4, v8
  v_add_u32 v29, s57, v8
  s_cmp_ge_u32 s54, 2
  s_cbranch_scc1 L_a2
  s_bfe_u32 s55, s68, 0x50002
  s_lshl_b32 s55, s55, 10
  s_and_b32 s56, s2, 4
  s_lshl_b32 s56, s56, 7
  s_add_u32 s55, s55, s56
  s_and_b32 s56, s68, 3
  s_lshl_b32 s56, s56, 7
  s_add_u32 s55, s55, s56
  s_add_u32 s55, s55, s59
  s_add_u32 s55, s55, 196608
  v_lshl_add_u32 v8, v2, 2, v7
  v_add_u32 v31, s55, v8
  s_branch L_a3
L_a2:
  s_lshr_b32 s56, s2, 6
  s_lshr_b32 s57, s2, 3
  s_add_u32 s55, s56, s57
  s_and_b32 s55, s55, 7
  s_mul_i32 s55, s55, 32
  s_mul_i32 s56, s56, 4
  s_cmp_eq_u32 s54, 3
  s_cselect_b32 s56, 16, s56
  s_cselect_b32 s57, 128, 0
  s_add_u32 s74, s55, s56
  v_bfe_u32 v8, v0, 2, 1
  v_lshl_add_u32 v9, v8, 9, v7
  v_add_u32 v31, 196608, v9
  v_mul_u32_u24 v8, 448, v8
  v_lshl_add_u32 v8, v6, 3, v8
  v_lshrrev_b32 v9, 3, v0
  v_lshl_add_u32 v8, v9, 5, v8
  v_add_u32 v30, s57, v8
L_a3:
  s_and_b32 s77, s48, 0xffff
  v_mov_b32 v132, 0x3f803f80
  v_mov_b32 v133, 0x3f803f80
  v_mov_b32 v134, 0x3f803f80
  v_mov_b32 v135, 0x3f803f80
  s_lshl_b32 s55, s54, 1
  s_lshl_b32 s78, 3, s55
  s_mov_b32 s79, 0
  s_cmp_ge_i32 s31, 16
  s_cbranch_scc1 L_pok_21
L_psp_22:
  ds_read_b32 v5, v3 offset:0
  s_waitcnt lgkmcnt(0)
  v_readfirstlane_b32 s31, v5
  s_sub_u32 s30, s30, 1
  s_cbranch_scc1 L_end
  s_cmp_lt_i32 s31, 16
  s_cbranch_scc1 L_psp_22
L_pok_21:
  ds_read_b128 v[72:75], v15 offset:0
  ds_read_b128 v[76:79], v16 offset:0
  ds_read_b128 v[80:83], v17 offset:0
  ds_read_b128 v[84:87], v18 offset:0
  ds_read_b128 v[88:91], v15 offset:4096
  ds_read_b128 v[92:95], v16 offset:4096
  ds_read_b128 v[96:99], v17 offset:4096
  ds_read_b128 v[100:103], v18 offset:4096
  s_mov_b64 exec, 1
  ds_add_u32 v3, v33 offset:276
  s_mov_b64 exec, -1
  s_cmp_ge_i32 s31, 16
  s_cbranch_scc1 L_pok_23
L_psp_24:
  ds_read_b32 v5, v3 offset:0
  s_waitcnt lgkmcnt(0)
  v_readfirstlane_b32 s31, v5
  s_sub_u32 s30, s30, 1
  s_cbranch_scc1 L_end
  s_cmp_lt_i32 s31, 16
  s_cbranch_scc1 L_psp_24
L_pok_23:
  s_and_b32 s55, s2, 7
  s_lshl_b32 s55, s55, 7
  s_add_u32 s55, s55, 188416
  v_and_b32 v5, 31, v0
  v_lshlrev_b32 v5, 2, v5
  buffer_load_dword v137, v5, s[36:39], s55 offen
  buffer_load_dwordx4 v[40:43], v12, s[36:39], 0 offen
  buffer_load_dwordx4 v[44:47], v12, s[36:39], 0 offen offset:1024
  buffer_load_dwordx4 v[48:51], v12, s[36:39], 0 offen offset:2048
  buffer_load_dwordx4 v[52:55], v12, s[36:39], 0 offen offset:3072
  s_waitcnt vmcnt(3)
  v_xor_b32 v40, s50, v40
  v_xor_b32 v41, s51, v41
  v_xor_b32 v42, s52, v42
  v_xor_b32 v43, s53, v43
  v_or3_b32 v5, v40, v41, v42
  v_or_b32 v5, v5, v43
  v_and_b32 v5, 4095, v5
  v_cmp_ne_u32 s[80:81], 0, v5
  s_waitcnt vmcnt(2)
  v_xor_b32 v44, s50, v44
  v_xor_b32 v45, s51, v45
  v_xor_b32 v46, s52, v46
  v_xor_b32 v47, s53, v47
  v_or3_b32 v5, v44, v45, v46
  v_or_b32 v5, v5, v47
  v_and_b32 v5, 4095, v5
  v_cmp_ne_u32 s[82:83], 0, v5
  s_waitcnt vmcnt(1)
  v_xor_b32 v48, s50, v48
  v_xor_b32 v49, s51, v49
  v_xor_b32 v50, s52, v50
  v_xor_b32 v51, s53, v51
  v_or3_b32 v5, v48, v49, v50
  v_or_b32 v5, v5, v51
  v_and_b32 v5, 4095, v5
  v_cmp_ne_u32 s[84:85], 0, v5
  s_waitcnt vmcnt(0)
  v_xor_b32 v52, s50, v52
  v_xor_b32 v53, s51, v53
  v_xor_b32 v54, s52, v54
  v_xor_b32 v55, s53, v55
  v_or3_b32 v5, v52, v53, v54
  v_or_b32 v5, v5, v55
  v_and_b32 v5, 4095, v5
  v_cmp_ne_u32 s[86:87], 0, v5
  s_or_b64 vcc, s[80:81], s[82:83]
  s_or_b64 vcc, vcc, s[84:85]
  s_or_b64 vcc, vcc, s[86:87]
  s_cbranch_vccz L_gd_26
L_g_25:
  s_mov_b64 exec, s[80:81]
  buffer_load_dwordx4 v[40:43], v12, s[36:39], 0 offen sc1
  s_mov_b64 exec, s[82:83]
  buffer_load_dwordx4 v[44:47], v12, s[36:39], 0 offen offset:1024 sc1
  s_mov_b64 exec, s[84:85]
  buffer_load_dwordx4 v[48:51], v12, s[36:39], 0 offen offset:2048 sc1
  s_mov_b64 exec, s[86:87]
  buffer_load_dwordx4 v[52:55], v12, s[36:39], 0 offen offset:3072 sc1
  s_mov_b64 exec, s[80:81]
  s_waitcnt vmcnt(3)
  v_xor_b32 v40, s50, v40
  v_xor_b32 v41, s51, v41
  v_xor_b32 v42, s52, v42
  v_xor_b32 v43, s53, v43
  v_or3_b32 v5, v40, v41, v42
  v_or_b32 v5, v5, v43
  v_and_b32 v5, 4095, v5
  v_cmp_ne_u32 s[80:81], 0, v5
  s_mov_b64 exec, s[82:83]
  s_waitcnt vmcnt(2)
  v_xor_b32 v44, s50, v44
  v_xor_b32 v45, s51, v45
  v_xor_b32 v46, s52, v46
  v_xor_b32 v47, s53, v47
  v_or3_b32 v5, v44, v45, v46
  v_or_b32 v5, v5, v47
  v_and_b32 v5, 4095, v5
  v_cmp_ne_u32 s[82:83], 0, v5
  s_mov_b64 exec, s[84:85]
  s_waitcnt vmcnt(1)
  v_xor_b32 v48, s50, v48
  v_xor_b32 v49, s51, v49
  v_xor_b32 v50, s52, v50
  v_xor_b32 v51, s53, v51
  v_or3_b32 v5, v48, v49, v50
  v_or_b32 v5, v5, v51
  v_and_b32 v5, 4095, v5
  v_cmp_ne_u32 s[84:85], 0, v5
  s_mov_b64 exec, s[86:87]
  s_waitcnt vmcnt(0)
  v_xor_b32 v52, s50, v52
  v_xor_b32 v53, s51, v53
  v_xor_b32 v54, s52, v54
  v_xor_b32 v55, s53, v55
  v_or3_b32 v5, v52, v53, v54
  v_or_b32 v5, v5, v55
  v_and_b32 v5, 4095, v5
  v_cmp_ne_u32 s[86:87], 0, v5
  s_or_b64 vcc, s[80:81], s[82:83]
  s_or_b64 vcc, vcc, s[84:85]
  s_or_b64 vcc, vcc, s[86:87]
  s_sub_u32 s30, s30, 16
  s_cbranch_scc1 L_end
  s_cbranch_vccnz L_g_25
L_gd_26:
  s_mov_b64 exec, -1
  s_waitcnt vmcnt(0)
  v_cmp_ne_u32 s[98:99], s71, v137
  v_pk_add_f32 v[40:41], v[40:41], v[44:45]
  v_pk_add_f32 v[42:43], v[42:43], v[46:47]
  v_pk_add_f32 v[48:49], v[48:49], v[52:53]
  v_pk_add_f32 v[50:51], v[50:51], v[54:55]
  v_pk_add_f32 v[40:41], v[40:41], v[48:49]
  v_pk_add_f32 v[42:43], v[42:43], v[50:51]
  v_cvt_pk_bf16_f32 v6, v40, v41
  v_cvt_pk_bf16_f32 v7, v42, v43
  ds_write_b64 v13, v[6:7]
  s_mov_b64 exec, 1
  ds_add_u32 v3, v33 offset:256
  s_mov_b64 exec, -1
L_csp_27:
  ds_read_b32 v5, v3 offset:256
  ds_read_b128 v[56:59], v14 offset:0
  ds_read_b128 v[60:63], v14 offset:64
  ds_read_b128 v[64:67], v14 offset:128
  ds_read_b128 v[68:71], v14 offset:192
  s_waitcnt lgkmcnt(0)
  v_readfirstlane_b32 s55, v5
  s_sub_u32 s30, s30, 1
  s_cbranch_scc1 L_end
  s_cmp_lt_u32 s55, 4
  s_cbranch_scc1 L_csp_27
  v_mfma_f32_16x16x32_bf16 v[104:107], v[72:75], v[56:59], 0
  v_mfma_f32_16x16x32_bf16 v[108:111], v[88:91], v[56:59], 0
  v_mfma_f32_16x16x32_bf16 v[104:107], v[76:79], v[60:63], v[104:107]
  v_mfma_f32_16x16x32_bf16 v[108:111], v[92:95], v[60:63], v[108:111]
  v_mfma_f32_16x16x32_bf16 v[104:107], v[80:83], v[64:67], v[104:107]
  v_mfma_f32_16x16x32_bf16 v[108:111], v[96:99], v[64:67], v[108:111]
  v_mfma_f32_16x16x32_bf16 v[104:107], v[84:87], v[68:71], v[104:107]
  v_mfma_f32_16x16x32_bf16 v[108:111], v[100:103], v[68:71], v[108:111]
  s_nop 7
  v_cndmask_b32 v40, v104, v108, s[64:65]
  v_cndmask_b32 v41, v105, v109, s[64:65]
  v_cndmask_b32 v42, v106, v110, s[64:65]
  v_cndmask_b32 v43, v107, v111, s[64:65]
  v_cvt_pk_bf16_f32 v6, v40, v41
  v_lshlrev_b32 v40, 16, v6
  v_and_b32 v41, 0xffff0000, v6
  v_cvt_pk_bf16_f32 v7, v42, v43
  v_lshlrev_b32 v42, 16, v7
  v_and_b32 v43, 0xffff0000, v7
  v_mul_f32 v40, 0x3db504f3, v40
  v_mul_f32 v41, 0x3db504f3, v41
  v_mul_f32 v42, 0x3db504f3, v42
  v_mul_f32 v43, 0x3db504f3, v43
  v_cvt_pk_bf16_f32 v6, v40, v41
  v_lshlrev_b32 v40, 16, v6
  v_and_b32 v41, 0xffff0000, v6
  v_cvt_pk_bf16_f32 v7, v42, v43
  v_lshlrev_b32 v42, 16, v7
  v_and_b32 v43, 0xffff0000, v7
  v_max3_f32 v6, v40, v41, v42
  v_max_f32 v6, v6, v43
  s_nop 1
  v_max_f32_dpp v6, v6, v6 row_ror:8 row_mask:0xf bank_mask:0xf
  v_mov_b32 v7, v6
  s_nop 1
  v_permlane16_swap_b32 v6, v7
  v_max_f32 v6, v6, v7
  v_mov_b32 v7, v6
  s_nop 1
  v_permlane32_swap_b32 v6, v7
  v_max_f32 v6, v6, v7
  v_mul_f32 v7, s76, v6
  v_fma_f32 v40, v40, s76, -v7
  v_fma_f32 v41, v41, s76, -v7
  v_fma_f32 v42, v42, s76, -v7
  v_fma_f32 v43, v43, s76, -v7
  v_exp_f32 v40, v40
  v_exp_f32 v41, v41
  v_exp_f32 v42, v42
  v_exp_f32 v43, v43
  v_cvt_pk_bf16_f32 v8, v40, v41
  v_cvt_pk_bf16_f32 v9, v42, v43
  ds_write_b64 v19, v[8:9]
  s_mov_b64 exec, 0xff
  ds_write_b32 v20, v6
  s_mov_b64 exec, 1
  ds_add_u32 v3, v33 offset:260
  s_mov_b64 exec, -1
  s_cmp_ge_i32 s31, 24
  s_cbranch_scc1 L_pok_28
L_psp_29:
  ds_read_b32 v5, v3 offset:0
  s_waitcnt lgkmcnt(0)
  v_readfirstlane_b32 s31, v5
  s_sub_u32 s30, s30, 1
  s_cbranch_scc1 L_end
  s_cmp_lt_i32 s31, 24
  s_cbranch_scc1 L_psp_29
L_pok_28:
  ds_read_b64_tr_b16 v[72:73], v24 offset:0
  ds_read_b64_tr_b16 v[74:75], v24 offset:1024
  ds_read_b64_tr_b16 v[76:77], v24 offset:8192
  ds_read_b64_tr_b16 v[78:79], v24 offset:9216
  ds_read_b64_tr_b16 v[80:81], v24 offset:16384
  ds_read_b64_tr_b16 v[82:83], v24 offset:17408
  ds_read_b64_tr_b16 v[84:85], v24 offset:24576
  ds_read_b64_tr_b16 v[86:87], v24 offset:25600
  ds_read_b64_tr_b16 v[88:89], v25 offset:0
  ds_read_b64_tr_b16 v[90:91], v25 offset:1024
  ds_read_b64_tr_b16 v[92:93], v25 offset:8192
  ds_read_b64_tr_b16 v[94:95], v25 offset:9216
  ds_read_b64_tr_b16 v[96:97], v25 offset:16384
  ds_read_b64_tr_b16 v[98:99], v25 offset:17408
  ds_read_b64_tr_b16 v[100:101], v25 offset:24576
  ds_read_b64_tr_b16 v[102:103], v25 offset:25600
  s_mov_b64 exec, 1
  ds_add_u32 v3, v33 offset:280
  s_mov_b64 exec, -1
L_csp_30:
  ds_read_b32 v5, v3 offset:260
  ds_read_b128 v[36:39], v23
  ds_read_b128 v[40:43], v21 offset:0
  ds_read_b128 v[56:59], v22 offset:0
  ds_read_b128 v[44:47], v21 offset:64
  ds_read_b128 v[60:63], v22 offset:64
  ds_read_b128 v[48:51], v21 offset:128
  ds_read_b128 v[64:67], v22 offset:128
  ds_read_b128 v[52:55], v21 offset:192
  ds_read_b128 v[68:71], v22 offset:192
  s_waitcnt lgkmcnt(0)
  v_readfirstlane_b32 s55, v5
  s_sub_u32 s30, s30, 1
  s_cbranch_scc1 L_end
  s_cmp_lt_u32 s55, 4
  s_cbranch_scc1 L_csp_30
  v_mfma_f32_16x16x32_bf16 v[104:107], v[72:75], v[40:43], 0
  v_max3_f32 v6, v36, v37, v38
  v_max_f32 v6, v6, v39
  v_mfma_f32_16x16x32_bf16 v[108:111], v[76:79], v[44:47], 0
  v_sub_f32 v36, v36, v6
  v_sub_f32 v37, v37, v6
  v_mfma_f32_16x16x32_bf16 v[112:115], v[80:83], v[48:51], 0
  v_sub_f32 v38, v38, v6
  v_sub_f32 v39, v39, v6
  v_mfma_f32_16x16x32_bf16 v[116:119], v[84:87], v[52:55], 0
  v_mul_f32 v36, s76, v36
  v_mul_f32 v37, s76, v37
  v_mfma_f32_16x16x32_bf16 v[104:107], v[88:91], v[56:59], v[104:107]
  v_mul_f32 v38, s76, v38
  v_mul_f32 v39, s76, v39
  v_mfma_f32_16x16x32_bf16 v[108:111], v[92:95], v[60:63], v[108:111]
  v_exp_f32 v36, v36
  v_exp_f32 v37, v37
  v_mfma_f32_16x16x32_bf16 v[112:115], v[96:99], v[64:67], v[112:115]
  v_exp_f32 v38, v38
  v_exp_f32 v39, v39
  v_mfma_f32_16x16x32_bf16 v[116:119], v[100:103], v[68:71], v[116:119]
  v_or_b32 v148, s50, v6
  v_mov_b32 v150, s52
  v_mov_b32 v151, s53
  v_mfma_f32_16x16x32_bf16 v[120:123], v[132:135], v[40:43], 0
  v_mul_f32 v72, v36, v104
  v_mul_f32 v73, v36, v105
  v_mul_f32 v74, v36, v106
  v_mul_f32 v75, v36, v107
  v_mfma_f32_16x16x32_bf16 v[124:127], v[132:135], v[44:47], 0
  v_fmac_f32 v72, v37, v108
  v_fmac_f32 v73, v37, v109
  v_fmac_f32 v74, v37, v110
  v_fmac_f32 v75, v37, v111
  v_mfma_f32_16x16x32_bf16 v[128:131], v[132:135], v[48:51], 0
  v_fmac_f32 v72, v38, v112
  v_fmac_f32 v73, v38, v113
  v_fmac_f32 v74, v38, v114
  v_fmac_f32 v75, v38, v115
  v_mfma_f32_16x16x32_bf16 v[144:147], v[132:135], v[52:55], 0
  v_fmac_f32 v72, v39, v116
  v_fmac_f32 v73, v39, v117
  v_fmac_f32 v74, v39, v118
  v_fmac_f32 v75, v39, v119
  v_and_or_b32 v76, v72, v4, s50
  v_and_or_b32 v77, v73, v4, s51
  v_and_or_b32 v78, v74, v4, s52
  v_and_or_b32 v79, v75, v4, s53
  v_mul_f32 v7, v36, v120
  v_fmac_f32 v7, v37, v124
  v_fmac_f32 v7, v38, v128
  v_fmac_f32 v7, v39, v144
  v_and_or_b32 v149, v7, v4, s51
  s_cmp_lg_u64 s[98:99], 0
  s_cbranch_scc1 L_pw_31
  buffer_store_dwordx4 v[76:79], v26, s[36:39], 0 offen
  s_mov_b64 exec, s[78:79]
  buffer_store_dwordx4 v[148:151], v27, s[36:39], 0 offen
  s_branch L_pd_32
L_pw_31:
  buffer_store_dwordx4 v[76:79], v26, s[36:39], 0 offen sc1
  s_mov_b64 exec, s[78:79]
  buffer_store_dwordx4 v[148:151], v27, s[36:39], 0 offen sc1
L_pd_32:
  s_mov_b64 exec, -1
  s_cmp_ge_u32 s54, 2
  s_cbranch_scc1 L_px
  ds_read_b32 v5, v3 offset:0
  s_waitcnt lgkmcnt(0)
  v_readfirstlane_b32 s31, v5
  s_add_u32 s59, s31, 3
  s_min_i32 s59, s59, 34
  s_cmp_ge_i32 s31, s59
  s_cbranch_scc1 L_pok_33
L_psp_34:
  ds_read_b32 v5, v3 offset:0
  s_waitcnt lgkmcnt(0)
  v_readfirstlane_b32 s31, v5
  s_sub_u32 s30, s30, 1
  s_cbranch_scc1 L_end
  s_cmp_lt_i32 s31, s59
  s_cbranch_scc1 L_psp_34
L_pok_33:
  s_mov_b64 s[80:81], -1
  s_mov_b64 s[82:83], -1
  s_mov_b64 s[84:85], -1
  s_mov_b64 exec, s[80:81]
  buffer_load_dwordx4 v[40:43], v29, s[36:39], 0 offen nt
  s_mov_b64 exec, s[82:83]
  buffer_load_dwordx4 v[44:47], v28, s[36:39], 0 offen nt
  s_mov_b64 exec, s[84:85]
  buffer_load_dwordx4 v[48:51], v28, s[36:39], 0 offen offset:2048 nt
  s_mov_b64 exec, -1
  ds_read_b32 v5, v3 offset:4
  s_waitcnt lgkmcnt(0)
  v_readfirstlane_b32 s59, v5
  s_add_u32 s59, s59, 3
  s_min_u32 s59, s59, 49
L_csp_37:
  ds_read_b32 v5, v3 offset:4
  s_waitcnt lgkmcnt(0)
  v_readfirstlane_b32 s55, v5
  s_sub_u32 s30, s30, 1
  s_cbranch_scc1 L_end
  s_cmp_lt_u32 s55, s59
  s_cbranch_scc1 L_csp_37
  s_cmp_lg_u64 s[98:99], 0
  s_cbranch_scc1 L_sa_38
  s_mov_b64 exec, s[80:81]
  buffer_load_dwordx4 v[52:55], v29, s[36:39], 0 offen nt
  s_mov_b64 exec, s[82:83]
  buffer_load_dwordx4 v[56:59], v28, s[36:39], 0 offen nt
  s_mov_b64 exec, s[84:85]
  buffer_load_dwordx4 v[60:63], v28, s[36:39], 0 offen offset:2048 nt
  s_branch L_sb_39
L_sa_38:
  s_mov_b64 exec, s[80:81]
  buffer_load_dwordx4 v[52:55], v29, s[36:39], 0 offen sc1
  s_mov_b64 exec, s[82:83]
  buffer_load_dwordx4 v[56:59], v28, s[36:39], 0 offen sc1
  s_mov_b64 exec, s[84:85]
  buffer_load_dwordx4 v[60:63], v28, s[36:39], 0 offen offset:2048 sc1
L_sb_39:
  s_mov_b64 exec, -1
L_s_35:
  s_mov_b64 exec, s[80:81]
  s_waitcnt vmcnt(5)
  v_xor_b32 v104, s50, v40
  v_xor_b32 v105, s51, v41
  v_xor_b32 v106, s52, v42
  v_xor_b32 v107, s53, v43
  v_or3_b32 v5, v104, v105, v106
  v_or_b32 v5, v5, v107
  v_and_b32 v5, 4095, v5
  v_cmp_ne_u32 s[80:81], 0, v5
  s_mov_b64 exec, s[82:83]
  s_waitcnt vmcnt(4)
  v_xor_b32 v108, s50, v44
  v_xor_b32 v109, s51, v45
  v_xor_b32 v110, s52, v46
  v_xor_b32 v111, s53, v47
  v_or3_b32 v5, v108, v109, v110
  v_or_b32 v5, v5, v111
  v_and_b32 v5, 4095, v5
  v_cmp_ne_u32 s[82:83], 0, v5
  s_mov_b64 exec, s[84:85]
  s_waitcnt vmcnt(3)
  v_xor_b32 v112, s50, v48
  v_xor_b32 v113, s51, v49
  v_xor_b32 v114, s52, v50
  v_xor_b32 v115, s53, v51
  v_or3_b32 v5, v112, v113, v114
  v_or_b32 v5, v5, v115
  v_and_b32 v5, 4095, v5
  v_cmp_ne_u32 s[84:85], 0, v5
  s_or_b64 vcc, s[80:81], s[82:83]
  s_or_b64 vcc, vcc, s[84:85]
  s_cbranch_scc0 L_sd_36
  s_cmp_lg_u64 s[98:99], 0
  s_cbranch_scc1 L_sa_40
  s_mov_b64 exec, s[80:81]
  buffer_load_dwordx4 v[40:43], v29, s[36:39], 0 offen nt
  s_mov_b64 exec, s[82:83]
  buffer_load_dwordx4 v[44:47], v28, s[36:39], 0 offen nt
  s_mov_b64 exec, s[84:85]
  buffer_load_dwordx4 v[48:51], v28, s[36:39], 0 offen offset:2048 nt
  s_branch L_sb_41
L_sa_40:
  s_mov_b64 exec, s[80:81]
  buffer_load_dwordx4 v[40:43], v29, s[36:39], 0 offen sc1
  s_mov_b64 exec, s[82:83]
  buffer_load_dwordx4 v[44:47], v28, s[36:39], 0 offen sc1
  s_mov_b64 exec, s[84:85]
  buffer_load_dwordx4 v[48:51], v28, s[36:39], 0 offen offset:2048 sc1
L_sb_41:
  s_mov_b64 exec, s[80:81]
  s_waitcnt vmcnt(5)
  v_xor_b32 v104, s50, v52
  v_xor_b32 v105, s51, v53
  v_xor_b32 v106, s52, v54
  v_xor_b32 v107, s53, v55
  v_or3_b32 v5, v104, v105, v106
  v_or_b32 v5, v5, v107
  v_and_b32 v5, 4095, v5
  v_cmp_ne_u32 s[80:81], 0, v5
  s_mov_b64 exec, s[82:83]
  s_waitcnt vmcnt(4)
  v_xor_b32 v108, s50, v56
  v_xor_b32 v109, s51, v57
  v_xor_b32 v110, s52, v58
  v_xor_b32 v111, s53, v59
  v_or3_b32 v5, v108, v109, v110
  v_or_b32 v5, v5, v111
  v_and_b32 v5, 4095, v5
  v_cmp_ne_u32 s[82:83], 0, v5
  s_mov_b64 exec, s[84:85]
  s_waitcnt vmcnt(3)
  v_xor_b32 v112, s50, v60
  v_xor_b32 v113, s51, v61
  v_xor_b32 v114, s52, v62
  v_xor_b32 v115, s53, v63
  v_or3_b32 v5, v112, v113, v114
  v_or_b32 v5, v5, v115
  v_and_b32 v5, 4095, v5
  v_cmp_ne_u32 s[84:85], 0, v5
  s_or_b64 vcc, s[80:81], s[82:83]
  s_or_b64 vcc, vcc, s[84:85]
  s_cbranch_scc0 L_sd_36
  s_cmp_lg_u64 s[98:99], 0
  s_cbranch_scc1 L_sa_42
  s_mov_b64 exec, s[80:81]
  buffer_load_dwordx4 v[52:55], v29, s[36:39], 0 offen nt
  s_mov_b64 exec, s[82:83]
  buffer_load_dwordx4 v[56:59], v28, s[36:39], 0 offen nt
  s_mov_b64 exec, s[84:85]
  buffer_load_dwordx4 v[60:63], v28, s[36:39], 0 offen offset:2048 nt
  s_branch L_sb_43
L_sa_42:
  s_mov_b64 exec, s[80:81]
  buffer_load_dwordx4 v[52:55], v29, s[36:39], 0 offen sc1
  s_mov_b64 exec, s[82:83]
  buffer_load_dwordx4 v[56:59], v28, s[36:39], 0 offen sc1
  s_mov_b64 exec, s[84:85]
  buffer_load_dwordx4 v[60:63], v28, s[36:39], 0 offen offset:2048 sc1
L_sb_43:
  s_sub_u32 s30, s30, 16
  s_cbranch_scc1 L_end
  s_branch L_s_35
L_sd_36:
  s_mov_b64 exec, -1
  v_max_f32_dpp v6, v104, v104 quad_perm:[1,0,3,2] row_mask:0xf bank_mask:0xf
  s_nop 1
  v_max_f32_dpp v6, v6, v6 row_ror:4 row_mask:0xf bank_mask:0xf
  s_nop 1
  v_max_f32_dpp v6, v6, v6 row_ror:8 row_mask:0xf bank_mask:0xf
  v_mov_b32 v7, v6
  s_nop 1
  v_permlane16_swap_b32 v6, v7
  v_max_f32 v6, v6, v7
  v_mov_b32 v7, v6
  s_nop 1
  v_permlane32_swap_b32 v6, v7
  v_max_f32 v6, v6, v7
  v_sub_f32 v8, v104, v6
  v_mul_f32 v8, s76, v8
  v_exp_f32 v8, v8
  s_nop 0
  v_mul_f32 v6, v8, v105
  v_mul_f32_dpp v108, v8, v108 quad_perm:[0,0,0,0] row_mask:0xf bank_mask:0xf
  v_mul_f32_dpp v109, v8, v109 quad_perm:[0,0,0,0] row_mask:0xf bank_mask:0xf
  v_add_f32_dpp v6, v6, v6 quad_perm:[1,0,3,2] row_mask:0xf bank_mask:0xf
  v_mul_f32_dpp v110, v8, v110 quad_perm:[0,0,0,0] row_mask:0xf bank_mask:0xf
  v_mul_f32_dpp v111, v8, v111 quad_perm:[0,0,0,0] row_mask:0xf bank_mask:0xf
  v_add_f32_dpp v6, v6, v6 row_ror:4 row_mask:0xf bank_mask:0xf
  v_fmac_f32_dpp v108, v8, v112 quad_perm:[1,1,1,1] row_mask:0xf bank_mask:0xf
  v_fmac_f32_dpp v109, v8, v113 quad_perm:[1,1,1,1] row_mask:0xf bank_mask:0xf
  v_add_f32_dpp v6, v6, v6 row_ror:8 row_mask:0xf bank_mask:0xf
  v_fmac_f32_dpp v110, v8, v114 quad_perm:[1,1,1,1] row_mask:0xf bank_mask:0xf
  v_fmac_f32_dpp v111, v8, v115 quad_perm:[1,1,1,1] row_mask:0xf bank_mask:0xf
  v_mov_b32 v7, v6
  v_permlane32_swap_b32 v108, v110
  v_permlane32_swap_b32 v109, v111
  v_permlane16_swap_b32 v6, v7
  v_add_f32 v108, v108, v110
  v_add_f32 v109, v109, v111
  v_add_f32 v6, v6, v7
  v_mov_b32 v7, v6
  v_permlane16_swap_b32 v108, v109
  s_nop 0
  v_permlane32_swap_b32 v6, v7
  v_add_f32 v108, v108, v109
  v_add_f32 v6, v6, v7
  v_rcp_f32 v6, v6
  v_add_f32_dpp v108, v108, v108 row_ror:4 row_mask:0xf bank_mask:0xf
  s_nop 1
  v_add_f32_dpp v108, v108, v108 row_ror:8 row_mask:0xf bank_mask:0xf
  v_mul_f32 v108, v108, v6
  v_cvt_pk_bf16_f32 v7, v108, v108
  v_and_b32 v7, 0xffff0000, v7
  v_or_b32 v7, s77, v7
  s_mov_b64 exec, s[62:63]
  buffer_store_dword v7, v31, s[36:39], 0 offen sc1
  s_mov_b64 exec, -1
  s_mov_b64 exec, 1
  ds_add_u32 v3, v33 offset:296
  s_mov_b64 exec, -1
  s_mov_b32 s90, 0
  s_waitcnt vmcnt(0)
  s_branch L_pxd
L_px:
  s_mov_b32 s58, 0x07060302
  v_lshrrev_b32 v6, 3, v0
  v_mov_b32 v108, 0
  v_mov_b32 v109, 0
  v_mov_b32 v110, 0
  v_mov_b32 v111, 0
  s_mov_b32 s55, 4
  s_mov_b64 s[82:83], -1
  s_cmp_eq_u32 s54, 3
  s_cbranch_scc1 L_px3
L_gsp_47:
  ds_read_b32 v5, v3 offset:0
  ds_read_b32 v8, v3 offset:296
  s_waitcnt lgkmcnt(0)
  v_readfirstlane_b32 s31, v5
  v_readfirstlane_b32 s59, v8
  s_sub_u32 s30, s30, 1
  s_cbranch_scc1 L_end
  s_cmp_ge_i32 s31, 51
  s_cbranch_scc1 L_gok_46
  s_cmp_lt_u32 s59, 2
  s_cbranch_scc1 L_gsp_47
  s_add_u32 s59, s31, 3
  s_min_i32 s59, s59, 51
  s_cmp_ge_i32 s31, s59
  s_cbranch_scc1 L_pok_48
L_psp_49:
  ds_read_b32 v5, v3 offset:0
  s_waitcnt lgkmcnt(0)
  v_readfirstlane_b32 s31, v5
  s_sub_u32 s30, s30, 1
  s_cbranch_scc1 L_end
  s_cmp_lt_i32 s31, s59
  s_cbranch_scc1 L_psp_49
L_pok_48:
L_gok_46:
  s_cmp_lt_i32 s31, 51
  s_cselect_b32 s90, 1, 0
  s_bfm_b64 s[82:83], 32, 0
  s_branch L_px2
L_px3:
  v_lshlrev_b32 v7, 2, v6
  s_cmp_ge_i32 s31, 51
  s_cbranch_scc1 L_pok_50
L_psp_51:
  ds_read_b32 v5, v3 offset:0
  s_waitcnt lgkmcnt(0)
  v_readfirstlane_b32 s31, v5
  s_sub_u32 s30, s30, 1
  s_cbranch_scc1 L_end
  s_cmp_lt_i32 s31, 51
  s_cbranch_scc1 L_psp_51
L_pok_50:
  ds_read_b32 v6, v7 offset:352
  s_waitcnt lgkmcnt(0)
  v_readlane_b32 s55, v6, 63
  v_and_b32 v6, 0xff, v6
  s_cmp_eq_u32 s55, 0
  s_cselect_b32 s90, 1, 0
L_px2:
  v_add_u32 v6, s74, v6
  s_lshl_b32 s55, s55, 3
  v_lshrrev_b32 v7, 3, v6
  v_and_b32 v6, 7, v6
  v_lshl_add_u32 v7, v7, 10, v31
  v_lshl_add_u32 v31, v6, 6, v7
  s_bfm_b64 s[80:81], s55, 0
  s_mov_b64 exec, s[80:81]
  buffer_load_dwordx4 v[108:111], v31, s[36:39], 0 offen sc1
  s_cmp_eq_u32 s90, 0
  s_cbranch_scc1 L_pe2
  s_waitcnt vmcnt(0)
  v_xor_b32 v6, v108, v109
  v_xor_b32 v7, v110, v111
  v_xor_b32 v8, v108, v110
  v_or3_b32 v6, v6, v7, v8
  v_xor_b32 v7, s77, v108
  v_or_b32 v6, v6, v7
  v_and_b32 v6, 0xffff, v6
  v_cmp_ne_u32 vcc, 0, v6
  s_cbranch_vccz L_pe1
  s_mov_b32 s90, 0
  s_mov_b64 exec, vcc
  buffer_load_dwordx4 v[108:111], v31, s[36:39], 0 offen sc1
  s_branch L_pe2
L_pe1:
  s_mov_b64 exec, s[82:83]
  v_perm_b32 v6, v109, v108, s58
  v_perm_b32 v7, v111, v110, s58
  ds_write_b64 v30, v[6:7] offset:10240
  s_mov_b64 exec, 1
  ds_add_u32 v3, v33 offset:264
  s_mov_b64 exec, -1
L_pe2:
  s_mov_b64 exec, -1
L_pxd:
L_csp_52:
  ds_read_b32 v5, v3 offset:0
  ds_read_b32 v6, v3 offset:380
  s_waitcnt lgkmcnt(0)
  v_readfirstlane_b32 s55, v5
  s_sub_u32 s30, s30, 1
  s_cbranch_scc1 L_end
  s_cmp_lt_u32 s55, 51
  s_cbranch_scc1 L_csp_52
  v_readfirstlane_b32 s74, v6
  s_add_u32 s72, s74, 49
  s_mov_b32 s55, 0
  s_min_u32 s73, s72, 47
  s_cmp_ge_u32 s55, s73
  s_cbranch_scc1 L_tok_53
L_csp_54:
  ds_read_b32 v5, v3 offset:4
  s_waitcnt lgkmcnt(0)
  v_readfirstlane_b32 s55, v5
  s_sub_u32 s30, s30, 1
  s_cbranch_scc1 L_end
  s_cmp_lt_u32 s55, s73
  s_cbranch_scc1 L_csp_54
L_tok_53:
  ds_read_b64_tr_b16 v[72:73], v140 offset:0
  ds_read_b64_tr_b16 v[74:75], v140 offset:1024
  ds_read_b64_tr_b16 v[88:89], v141 offset:0
  ds_read_b64_tr_b16 v[90:91], v141 offset:1024
  s_min_u32 s73, s72, 49
  s_cmp_ge_u32 s55, s73
  s_cbranch_scc1 L_tok_55
L_csp_56:
  ds_read_b32 v5, v3 offset:4
  s_waitcnt lgkmcnt(0)
  v_readfirstlane_b32 s55, v5
  s_sub_u32 s30, s30, 1
  s_cbranch_scc1 L_end
  s_cmp_lt_u32 s55, s73
  s_cbranch_scc1 L_csp_56
L_tok_55:
  ds_read_b64_tr_b16 v[76:77], v140 offset:8192
  ds_read_b64_tr_b16 v[78:79], v140 offset:9216
  ds_read_b64_tr_b16 v[92:93], v141 offset:8192
  ds_read_b64_tr_b16 v[94:95], v141 offset:9216
  s_cmp_le_u32 s74, 0
  s_cbranch_scc1 L_rdd
  s_min_u32 s73, s72, 51
  s_cmp_ge_u32 s55, s73
  s_cbranch_scc1 L_tok_57
L_csp_58:
  ds_read_b32 v5, v3 offset:4
  s_waitcnt lgkmcnt(0)
  v_readfirstlane_b32 s55, v5
  s_sub_u32 s30, s30, 1
  s_cbranch_scc1 L_end
  s_cmp_lt_u32 s55, s73
  s_cbranch_scc1 L_csp_58
L_tok_57:
  ds_read_b64_tr_b16 v[80:81], v140 offset:16384
  ds_read_b64_tr_b16 v[82:83], v140 offset:17408
  ds_read_b64_tr_b16 v[96:97], v141 offset:16384
  ds_read_b64_tr_b16 v[98:99], v141 offset:17408
  s_cmp_le_u32 s74, 2
  s_cbranch_scc1 L_rdd
  s_min_u32 s73, s72, 53
  s_cmp_ge_u32 s55, s73
  s_cbranch_scc1 L_tok_59
L_csp_60:
  ds_read_b32 v5, v3 offset:4
  s_waitcnt lgkmcnt(0)
  v_readfirstlane_b32 s55, v5
  s_sub_u32 s30, s30, 1
  s_cbranch_scc1 L_end
  s_cmp_lt_u32 s55, s73
  s_cbranch_scc1 L_csp_60
L_tok_59:
  ds_read_b64_tr_b16 v[84:85], v140 offset:24576
  ds_read_b64_tr_b16 v[86:87], v140 offset:25600
  ds_read_b64_tr_b16 v[100:101], v141 offset:24576
  ds_read_b64_tr_b16 v[102:103], v141 offset:25600
  s_cmp_le_u32 s74, 4
  s_cbranch_scc1 L_rdd
  s_min_u32 s73, s72, 55
  s_cmp_ge_u32 s55, s73
  s_cbranch_scc1 L_tok_61
L_csp_62:
  ds_read_b32 v5, v3 offset:4
  s_waitcnt lgkmcnt(0)
  v_readfirstlane_b32 s55, v5
  s_sub_u32 s30, s30, 1
  s_cbranch_scc1 L_end
  s_cmp_lt_u32 s55, s73
  s_cbranch_scc1 L_csp_62
L_tok_61:
  ds_read_b64_tr_b16 v[120:121], v140 offset:32768
  ds_read_b64_tr_b16 v[122:123], v140 offset:33792
  ds_read_b64_tr_b16 v[128:129], v141 offset:32768
  ds_read_b64_tr_b16 v[130:131], v141 offset:33792
  s_cmp_le_u32 s74, 6
  s_cbranch_scc1 L_rdd
  s_min_u32 s73, s72, 57
  s_cmp_ge_u32 s55, s73
  s_cbranch_scc1 L_tok_63
L_csp_64:
  ds_read_b32 v5, v3 offset:4
  s_waitcnt lgkmcnt(0)
  v_readfirstlane_b32 s55, v5
  s_sub_u32 s30, s30, 1
  s_cbranch_scc1 L_end
  s_cmp_lt_u32 s55, s73
  s_cbranch_scc1 L_csp_64
L_tok_63:
  ds_read_b64_tr_b16 v[124:125], v140 offset:40960
  ds_read_b64_tr_b16 v[126:127], v140 offset:41984
  ds_read_b64_tr_b16 v[132:133], v141 offset:40960
  ds_read_b64_tr_b16 v[134:135], v141 offset:41984
L_rdd:
  s_cmp_lt_u32 s54, 2
  s_cbranch_scc1 L_pxw
  s_cmp_lg_u32 s90, 0
  s_cbranch_scc1 L_pxw
  s_mov_b64 exec, s[80:81]
  s_branch L_px1_45
L_px0_44:
  s_sub_u32 s30, s30, 16
  s_cbranch_scc1 L_end
  s_mov_b64 exec, vcc
  buffer_load_dwordx4 v[108:111], v31, s[36:39], 0 offen sc1
L_px1_45:
  s_waitcnt vmcnt(0)
  v_xor_b32 v6, v108, v109
  v_xor_b32 v7, v110, v111
  v_xor_b32 v8, v108, v110
  v_or3_b32 v6, v6, v7, v8
  v_xor_b32 v7, s77, v108
  v_or_b32 v6, v6, v7
  v_and_b32 v6, 0xffff, v6
  v_cmp_ne_u32 vcc, 0, v6
  s_cbranch_vccnz L_px0_44
  s_mov_b64 exec, s[82:83]
  v_perm_b32 v6, v109, v108, s58
  v_perm_b32 v7, v111, v110, s58
  ds_write_b64 v30, v[6:7] offset:10240
  s_mov_b64 exec, 1
  ds_add_u32 v3, v33 offset:264
  s_mov_b64 exec, -1
L_pxw:
L_csp_65:
  ds_read_b32 v5, v3 offset:264
  ds_read_b128 v[40:43], v153 offset:0
  ds_read_b128 v[44:47], v153 offset:64
  ds_read_b128 v[48:51], v153 offset:128
  ds_read_b128 v[52:55], v153 offset:192
  ds_read_b128 v[56:59], v153 offset:256
  ds_read_b128 v[60:63], v153 offset:320
  ds_read_b32 v158, v155 offset:6784
  s_waitcnt lgkmcnt(0)
  v_readfirstlane_b32 s55, v5
  s_sub_u32 s30, s30, 1
  s_cbranch_scc1 L_end
  s_cmp_lt_u32 s55, 4
  s_cbranch_scc1 L_csp_65
  v_mfma_f32_16x16x32_bf16 v[104:107], v[72:75], v[40:43], 0
  v_mfma_f32_16x16x32_bf16 v[108:111], v[88:91], v[40:43], 0
  v_mfma_f32_16x16x32_bf16 v[104:107], v[76:79], v[44:47], v[104:107]
  v_mfma_f32_16x16x32_bf16 v[108:111], v[92:95], v[44:47], v[108:111]
  s_cmp_le_u32 s74, 0
  s_cbranch_scc1 L_comb
  v_mfma_f32_16x16x32_bf16 v[104:107], v[80:83], v[48:51], v[104:107]
  v_mfma_f32_16x16x32_bf16 v[108:111], v[96:99], v[48:51], v[108:111]
  s_cmp_le_u32 s74, 2
  s_cbranch_scc1 L_comb
  v_mfma_f32_16x16x32_bf16 v[104:107], v[84:87], v[52:55], v[104:107]
  v_mfma_f32_16x16x32_bf16 v[108:111], v[100:103], v[52:55], v[108:111]
  s_cmp_le_u32 s74, 4
  s_cbranch_scc1 L_comb
  v_mfma_f32_16x16x32_bf16 v[104:107], v[120:123], v[56:59], v[104:107]
  v_mfma_f32_16x16x32_bf16 v[108:111], v[128:131], v[56:59], v[108:111]
  s_cmp_le_u32 s74, 6
  s_cbranch_scc1 L_comb
  v_mfma_f32_16x16x32_bf16 v[104:107], v[124:127], v[60:63], v[104:107]
  v_mfma_f32_16x16x32_bf16 v[108:111], v[132:135], v[60:63], v[108:111]
  s_branch L_comb
L_F:
  s_mov_b32 s64, 0xff00ff00
  s_mov_b32 s65, 0xff00ff00
  s_mov_b32 s66, 0xcccccccc
  s_mov_b32 s67, 0xcccccccc
  s_mov_b64 s[44:45], s[24:25]
  s_mov_b32 s46, 4096
  s_mov_b32 s47, 0x20000
  s_and_b32 s68, s2, 7
  s_lshl_b32 s68, s68, 5
  s_lshr_b32 s55, s2, 3
  s_add_u32 s68, s68, s55
  v_add_u32 v140, 114688, v24
  v_xor_b32 v141, 32, v140
  v_and_b32 v5, 1, v0
  v_lshlrev_b32 v6, 8, v5
  v_lshl_add_u32 v6, v2, 4, v6
  v_add_u32 v153, 1024, v6
  v_lshlrev_b32 v155, 3, v5
  s_lshl_b32 s55, s54, 8
  s_add_u32 s55, s55, 9216
  v_and_b32 v6, 3, v0
  v_lshlrev_b32 v6, 6, v6
  v_lshl_add_u32 v6, v2, 4, v6
  v_add_u32 v154, s55, v6
  v_lshlrev_b32 v156, 4, v0
  s_and_b32 s55, s2, 7
  s_lshl_b32 s55, s55, 15
  s_lshr_b32 s56, s2, 3
  s_lshl_b32 s56, s56, 7
  s_add_u32 s55, s55, s56
  s_add_u32 s55, s55, 2097152
  v_lshrrev_b32 v5, 3, v0
  v_lshlrev_b32 v5, 12, v5
  v_and_b32 v6, 7, v0
  v_lshl_add_u32 v5, v6, 4, v5
  v_add_u32 v157, s55, v5
  s_cmp_lg_u32 s54, 0
  s_cbranch_scc1 L_noid
  s_lshl_b32 s55, s68, 2
  s_add_u32 s55, s55, 188416
  v_mov_b32 v5, s71
  s_mov_b64 exec, 1
  buffer_store_dword v5, off, s[36:39], s55
  s_lshl_b32 s56, s48, 8
  v_mov_b32 v6, s56
  s_lshr_b64 s[56:57], s[48:49], 24
  v_mov_b32 v7, s56
  s_cmp_lt_u32 s2, 64
  s_cselect_b32 exec_lo, 1, 0
  s_and_b32 s55, s2, 7
  s_mul_i32 s55, s55, 8
  s_lshr_b32 s56, s2, 3
  s_add_u32 s55, s55, s56
  s_lshl_b32 s55, s55, 7
  s_add_u32 s55, s55, 229376
  buffer_store_dwordx2 v[6:7], off, s[36:39], s55 sc1
  s_mov_b64 exec, -1
L_noid:
  v_mov_b32 v40, 0
  v_mov_b32 v41, 0
  v_mov_b32 v42, 0
  v_mov_b32 v43, 0
  v_mov_b32 v44, 0
  v_mov_b32 v45, 0
  v_mov_b32 v46, 0
  v_mov_b32 v47, 0
  v_mov_b32 v48, 0
  v_mov_b32 v49, 0
  v_mov_b32 v50, 0
  v_mov_b32 v51, 0
  v_mov_b32 v52, 0
  v_mov_b32 v53, 0
  v_mov_b32 v54, 0
  v_mov_b32 v55, 0
  v_mov_b32 v56, 0
  v_mov_b32 v57, 0
  v_mov_b32 v58, 0
  v_mov_b32 v59, 0
  v_mov_b32 v60, 0
  v_mov_b32 v61, 0
  v_mov_b32 v62, 0
  v_mov_b32 v63, 0
  v_mov_b32 v64, 0
  v_mov_b32 v65, 0
  v_mov_b32 v66, 0
  v_mov_b32 v67, 0
  v_mov_b32 v68, 0
  v_mov_b32 v69, 0
  v_mov_b32 v70, 0
  v_mov_b32 v71, 0
  v_mov_b32 v120, 0
  v_mov_b32 v121, 0
  v_mov_b32 v122, 0
  v_mov_b32 v123, 0
  v_mov_b32 v124, 0
  v_mov_b32 v125, 0
  v_mov_b32 v126, 0
  v_mov_b32 v127, 0
  v_mov_b32 v128, 0
  v_mov_b32 v129, 0
  v_mov_b32 v130, 0
  v_mov_b32 v131, 0
  v_mov_b32 v132, 0
  v_mov_b32 v133, 0
  v_mov_b32 v134, 0
  v_mov_b32 v135, 0
  v_mov_b32 v144, 0
  v_mov_b32 v145, 0
  v_mov_b32 v146, 0
  v_mov_b32 v147, 0
  v_mov_b32 v148, 0
  v_mov_b32 v149, 0
  v_mov_b32 v150, 0
  v_mov_b32 v151, 0
  s_and_b32 s55, s68, -2
  s_mul_i32 s55, s55, 7
  s_lshr_b32 s70, s55, 5
  s_and_b32 s69, s55, 31
  s_mov_b32 s57, 0x00f000f0
  s_mov_b64 exec, -1
  v_add_u32 v11, 86016, v10
  v_add_u32 v12, 20480, v10
  s_cmp_ge_u32 s69, 19
  s_cselect_b32 s72, 0x00330033, s60
  s_mov_b32 s73, s72
  s_mul_i32 s55, s70, 149808
  s_lshr_b32 s55, s55, 16
  s_lshr_b32 s56, s68, 1
  s_sub_u32 s55, s56, s55
  s_lshl_b32 s55, s55, 7
  s_lshl2_add_u32 s56, s70, s54
  s_lshl_b32 s56, s56, 10
  s_and_b32 s57, s68, 1
  s_lshl_b32 s57, s57, 9
  s_add_u32 s56, s56, s57
  s_add_u32 s56, s56, 262144
  v_mov_b32 v6, s55
  v_mov_b32 v7, 4096
  s_mov_b32 s58, 0xf0f0f0f0
  s_mov_b32 s59, 0xf0f0f0f0
  v_cndmask_b32 v6, v6, v7, s[58:59]
  v_and_b32 v5, 1, v0
  v_lshlrev_b32 v5, 6, v5
  v_lshl_add_u32 v5, v2, 4, v5
  v_add3_u32 v13, v5, v6, s56
  s_lshr_b32 s74, s2, 3
  s_mul_i32 s55, s74, 7
  s_add_u32 s55, s55, s54
  s_lshl_b32 s56, s55, 10
  s_add_u32 s56, s56, 262144
  v_add_u32 v14, s56, v156
  v_add_u32 v18, 4096, v14
  s_lshr_b32 s55, s55, 2
  s_mul_i32 s56, s55, 9363
  s_lshr_b32 s56, s56, 16
  s_mul_i32 s56, s56, 7
  s_sub_u32 s55, s55, s56
  s_mov_b32 s56, 0x00ffffff
  s_cmp_eq_u32 s55, 3
  s_cselect_b32 s78, -1, s56
  s_mov_b32 s79, s78
  s_cmp_eq_u32 s55, 2
  s_cselect_b32 s88, -1, s56
  s_cmp_eq_u32 s54, 3
  s_cselect_b32 s88, 0, s88
  s_mov_b32 s89, s88
  v_bfe_u32 v6, v0, 2, 1
  v_lshlrev_b32 v6, 8, v6
  v_lshrrev_b32 v7, 5, v0
  v_lshl_add_u32 v6, v7, 7, v6
  v_and_b32 v7, 3, v0
  v_lshl_add_u32 v6, v7, 3, v6
  v_bfe_u32 v7, v0, 3, 2
  v_lshl_add_u32 v6, v7, 1, v6
  s_lshl_b32 s55, s54, 5
  v_add_u32 v16, s55, v6
  s_mov_b64 s[40:41], s[22:23]
  s_mov_b32 s42, 2048
  s_mov_b32 s43, 0x20000
  s_lshr_b32 s57, s68, 2
  s_lshl_b32 s55, s57, 12
  s_add_u32 s55, s55, 2097152
  v_add_u32 v22, s55, v156
  s_xor_b32 s57, s57, 0
  s_lshl_b32 s55, s57, 5
  v_bfe_u32 v5, v0, 2, 1
  v_lshlrev_b32 v5, 11, v5
  v_lshl_add_u32 v5, v2, 1, v5
  v_and_b32 v6, 3, v0
  v_lshl_add_u32 v5, v6, 3, v5
  v_add_u32 v23, s55, v5
  s_mov_b32 s57, 0
  s_mul_i32 s56, s69, 64
  s_add_u32 s56, s56, 147456
  v_bfe_u32 v5, v0, 2, 1
  v_mul_u32_u24 v5, 2048, v5
  v_sub_u32 v5, v9, v5
  v_mad_u32_u24 v5, v2, s57, v5
  v_add_u32 v34, s56, v5
  s_mov_b32 s57, 0x00f000f0
L_csp_75:
  ds_read_b32 v5, v3 offset:292
  s_waitcnt lgkmcnt(0)
  v_readfirstlane_b32 s55, v5
  s_sub_u32 s30, s30, 1
  s_cbranch_scc1 L_end
  s_cmp_lt_u32 s55, 4
  s_cbranch_scc1 L_csp_75
  s_cmp_ge_u32 s69, 32
  s_cselect_b32 exec_lo, s57, s62
  s_cselect_b32 exec_hi, s57, s62
  ds_read_b128 v[40:43], v34 offset:0
  s_cmp_ge_u32 s69, 31
  s_cselect_b32 exec_lo, s57, s62
  s_cselect_b32 exec_hi, s57, s62
  ds_read_b128 v[44:47], v34 offset:64
  s_cmp_ge_u32 s69, 30
  s_cselect_b32 exec_lo, s57, s62
  s_cselect_b32 exec_hi, s57, s62
  ds_read_b128 v[48:51], v34 offset:128
  s_cmp_ge_u32 s69, 29
  s_cselect_b32 exec_lo, s57, s62
  s_cselect_b32 exec_hi, s57, s62
  ds_read_b128 v[52:55], v34 offset:192
  s_cmp_ge_u32 s69, 28
  s_cselect_b32 exec_lo, s57, s62
  s_cselect_b32 exec_hi, s57, s62
  ds_read_b128 v[56:59], v34 offset:256
  s_cmp_ge_u32 s69, 27
  s_cselect_b32 exec_lo, s57, s62
  s_cselect_b32 exec_hi, s57, s62
  ds_read_b128 v[60:63], v34 offset:320
  s_cmp_ge_u32 s69, 26
  s_cselect_b32 exec_lo, s57, s62
  s_cselect_b32 exec_hi, s57, s62
  ds_read_b128 v[64:67], v34 offset:384
  s_cmp_ge_u32 s69, 25
  s_cselect_b32 exec_lo, s57, s62
  s_cselect_b32 exec_hi, s57, s62
  ds_read_b128 v[68:71], v34 offset:448
  s_cmp_ge_u32 s69, 24
  s_cselect_b32 exec_lo, s57, s62
  s_cselect_b32 exec_hi, s57, s62
  ds_read_b128 v[120:123], v34 offset:512
  s_cmp_ge_u32 s69, 23
  s_cselect_b32 exec_lo, s57, s62
  s_cselect_b32 exec_hi, s57, s62
  ds_read_b128 v[124:127], v34 offset:576
  s_cmp_ge_u32 s69, 22
  s_cselect_b32 exec_lo, s57, s62
  s_cselect_b32 exec_hi, s57, s62
  ds_read_b128 v[128:131], v34 offset:640
  s_cmp_ge_u32 s69, 21
  s_cselect_b32 exec_lo, s57, s62
  s_cselect_b32 exec_hi, s57, s62
  ds_read_b128 v[132:135], v34 offset:704
  s_cmp_ge_u32 s69, 20
  s_cselect_b32 exec_lo, s57, s62
  s_cselect_b32 exec_hi, s57, s62
  ds_read_b128 v[144:147], v34 offset:768
  s_cmp_ge_u32 s69, 19
  s_cselect_b32 exec_lo, s57, s62
  s_cselect_b32 exec_hi, s57, s62
  ds_read_b128 v[148:151], v34 offset:832
  s_mov_b64 exec, -1
  s_cmp_lt_u32 s54, 2
  s_cbranch_scc1 L_nog
  s_and_b32 s55, s54, 1
  s_lshl_b32 s56, s55, 3
  s_lshl_b32 s55, s55, 11
  s_add_u32 s55, s55, 147456
  v_lshlrev_b32 v5, 5, v0
  buffer_load_dwordx4 v[80:83], v5, s[40:43], 0 offen
  buffer_load_dwordx4 v[84:87], v5, s[40:43], 0 offen offset:16
  v_add_u32 v5, s55, v5
  ds_read_b128 v[72:75], v5
  ds_read_b128 v[76:79], v5 offset:16
  v_mov_b32 v9, 0
  s_waitcnt vmcnt(0) lgkmcnt(0)
  v_lshlrev_b32 v5, 16, v72
  v_lshlrev_b32 v6, 16, v80
  v_and_b32 v7, 0xffff0000, v72
  v_and_b32 v8, 0xffff0000, v80
  v_mul_f32 v5, v5, v6
  v_mul_f32 v7, v7, v8
  v_cvt_pk_bf16_f32 v6, v5, v7
  v_lshlrev_b32 v5, 16, v6
  v_and_b32 v7, 0xffff0000, v6
  v_add_f32 v9, v9, v5
  v_add_f32 v9, v9, v7
  v_lshlrev_b32 v5, 16, v73
  v_lshlrev_b32 v6, 16, v81
  v_and_b32 v7, 0xffff0000, v73
  v_and_b32 v8, 0xffff0000, v81
  v_mul_f32 v5, v5, v6
  v_mul_f32 v7, v7, v8
  v_cvt_pk_bf16_f32 v6, v5, v7
  v_lshlrev_b32 v5, 16, v6
  v_and_b32 v7, 0xffff0000, v6
  v_add_f32 v9, v9, v5
  v_add_f32 v9, v9, v7
  v_lshlrev_b32 v5, 16, v74
  v_lshlrev_b32 v6, 16, v82
  v_and_b32 v7, 0xffff0000, v74
  v_and_b32 v8, 0xffff0000, v82
  v_mul_f32 v5, v5, v6
  v_mul_f32 v7, v7, v8
  v_cvt_pk_bf16_f32 v6, v5, v7
  v_lshlrev_b32 v5, 16, v6
  v_and_b32 v7, 0xffff0000, v6
  v_add_f32 v9, v9, v5
  v_add_f32 v9, v9, v7
  v_lshlrev_b32 v5, 16, v75
  v_lshlrev_b32 v6, 16, v83
  v_and_b32 v7, 0xffff0000, v75
  v_and_b32 v8, 0xffff0000, v83
  v_mul_f32 v5, v5, v6
  v_mul_f32 v7, v7, v8
  v_cvt_pk_bf16_f32 v6, v5, v7
  v_lshlrev_b32 v5, 16, v6
  v_and_b32 v7, 0xffff0000, v6
  v_add_f32 v9, v9, v5
  v_add_f32 v9, v9, v7
  v_lshlrev_b32 v5, 16, v76
  v_lshlrev_b32 v6, 16, v84
  v_and_b32 v7, 0xffff0000, v76
  v_and_b32 v8, 0xffff0000, v84
  v_mul_f32 v5, v5, v6
  v_mul_f32 v7, v7, v8
  v_cvt_pk_bf16_f32 v6, v5, v7
  v_lshlrev_b32 v5, 16, v6
  v_and_b32 v7, 0xffff0000, v6
  v_add_f32 v9, v9, v5
  v_add_f32 v9, v9, v7
  v_lshlrev_b32 v5, 16, v77
  v_lshlrev_b32 v6, 16, v85
  v_and_b32 v7, 0xffff0000, v77
  v_and_b32 v8, 0xffff0000, v85
  v_mul_f32 v5, v5, v6
  v_mul_f32 v7, v7, v8
  v_cvt_pk_bf16_f32 v6, v5, v7
  v_lshlrev_b32 v5, 16, v6
  v_and_b32 v7, 0xffff0000, v6
  v_add_f32 v9, v9, v5
  v_add_f32 v9, v9, v7
  v_lshlrev_b32 v5, 16, v78
  v_lshlrev_b32 v6, 16, v86
  v_and_b32 v7, 0xffff0000, v78
  v_and_b32 v8, 0xffff0000, v86
  v_mul_f32 v5, v5, v6
  v_mul_f32 v7, v7, v8
  v_cvt_pk_bf16_f32 v6, v5, v7
  v_lshlrev_b32 v5, 16, v6
  v_and_b32 v7, 0xffff0000, v6
  v_add_f32 v9, v9, v5
  v_add_f32 v9, v9, v7
  v_lshlrev_b32 v5, 16, v79
  v_lshlrev_b32 v6, 16, v87
  v_and_b32 v7, 0xffff0000, v79
  v_and_b32 v8, 0xffff0000, v87
  v_mul_f32 v5, v5, v6
  v_mul_f32 v7, v7, v8
  v_cvt_pk_bf16_f32 v6, v5, v7
  v_lshlrev_b32 v5, 16, v6
  v_and_b32 v7, 0xffff0000, v6
  v_add_f32 v9, v9, v5
  v_add_f32 v9, v9, v7
  s_nop 1
  v_add_f32_dpp v9, v9, v9 quad_perm:[1,0,3,2] row_mask:0xf bank_mask:0xf
  s_nop 1
  v_add_f32_dpp v9, v9, v9 quad_perm:[2,3,0,1] row_mask:0xf bank_mask:0xf
  s_nop 1
  v_add_f32_dpp v9, v9, v9 row_ror:4 row_mask:0xf bank_mask:0xf
  s_nop 1
  v_add_f32_dpp v9, v9, v9 row_ror:8 row_mask:0xf bank_mask:0xf
  v_mov_b32 v8, v9
  s_nop 1
  v_permlane16_swap_b32 v9, v8
  v_add_f32 v9, v9, v8
  v_mov_b32 v8, v9
  s_nop 1
  v_permlane32_swap_b32 v9, v8
  v_add_f32 v9, v9, v8
  v_cvt_pk_bf16_f32 v9, v9, v9
  v_lshlrev_b32 v9, 16, v9
  v_mul_f32 v9, 0xbfb8aa3b, v9
  v_exp_f32 v9, v9
  s_nop 0
  v_add_f32 v9, 1.0, v9
  v_rcp_f32 v9, v9
  s_nop 0
  v_cvt_pk_bf16_f32 v8, v9, v9
  v_lshlrev_b32 v8, 16, v8
  v_sub_f32 v9, 1.0, v8
  v_cvt_pk_bf16_f32 v9, v9, v9
  v_lshlrev_b32 v9, 16, v9
  v_mov_b32 v5, s56
  ds_write_b64 v5, v[8:9] offset:6784
  s_mov_b64 exec, 1
  ds_add_u32 v3, v33 offset:264
  s_mov_b64 exec, -1
  s_mov_b64 exec, 1
  ds_add_u32 v3, v33 offset:268
  s_mov_b64 exec, -1
L_nog:
  s_waitcnt vmcnt(0)
  s_cmp_ge_i32 s31, 28
  s_cbranch_scc1 L_pok_76
L_psp_77:
  ds_read_b32 v5, v3 offset:0
  s_waitcnt lgkmcnt(0)
  v_readfirstlane_b32 s31, v5
  s_sub_u32 s30, s30, 1
  s_cbranch_scc1 L_end
  s_cmp_lt_i32 s31, 28
  s_cbranch_scc1 L_psp_77
L_pok_76:
  ds_read_b64_tr_b16 v[72:73], v11 offset:0
  ds_read_b64_tr_b16 v[74:75], v11 offset:512
  ds_read_b64_tr_b16 v[76:77], v11 offset:4096
  ds_read_b64_tr_b16 v[78:79], v11 offset:4608
  ds_read_b64_tr_b16 v[80:81], v11 offset:8192
  ds_read_b64_tr_b16 v[82:83], v11 offset:8704
  ds_read_b64_tr_b16 v[84:85], v11 offset:12288
  ds_read_b64_tr_b16 v[86:87], v11 offset:12800
  s_waitcnt lgkmcnt(6)
  v_mfma_f32_16x16x32_bf16 v[104:107], v[72:75], v[40:43], 0
  s_waitcnt lgkmcnt(4)
  v_mfma_f32_16x16x32_bf16 v[104:107], v[76:79], v[44:47], v[104:107]
  s_waitcnt lgkmcnt(2)
  v_mfma_f32_16x16x32_bf16 v[104:107], v[80:83], v[48:51], v[104:107]
  s_waitcnt lgkmcnt(0)
  v_mfma_f32_16x16x32_bf16 v[104:107], v[84:87], v[52:55], v[104:107]
  s_cmp_ge_i32 s31, 31
  s_cbranch_scc1 L_pok_78
L_psp_79:
  ds_read_b32 v5, v3 offset:0
  s_waitcnt lgkmcnt(0)
  v_readfirstlane_b32 s31, v5
  s_sub_u32 s30, s30, 1
  s_cbranch_scc1 L_end
  s_cmp_lt_i32 s31, 31
  s_cbranch_scc1 L_psp_79
L_pok_78:
  ds_read_b64_tr_b16 v[88:89], v11 offset:16384
  ds_read_b64_tr_b16 v[90:91], v11 offset:16896
  ds_read_b64_tr_b16 v[92:93], v11 offset:20480
  ds_read_b64_tr_b16 v[94:95], v11 offset:20992
  ds_read_b64_tr_b16 v[96:97], v11 offset:24576
  ds_read_b64_tr_b16 v[98:99], v11 offset:25088
  s_waitcnt lgkmcnt(4)
  v_mfma_f32_16x16x32_bf16 v[104:107], v[88:91], v[56:59], v[104:107]
  s_waitcnt lgkmcnt(2)
  v_mfma_f32_16x16x32_bf16 v[104:107], v[92:95], v[60:63], v[104:107]
  s_waitcnt lgkmcnt(0)
  v_mfma_f32_16x16x32_bf16 v[104:107], v[96:99], v[64:67], v[104:107]
  s_mov_b64 exec, 1
  ds_add_u32 v3, v33 offset:280
  s_mov_b64 exec, -1
  s_and_b32 s55, s2, 7
  s_lshl_b32 s55, s55, 7
  s_add_u32 s55, s55, 188416
  v_and_b32 v5, 31, v0
  v_lshlrev_b32 v5, 2, v5
  buffer_load_dword v137, v5, s[36:39], s55 offen
  s_cmp_ge_i32 s31, 35
  s_cbranch_scc1 L_pok_80
L_psp_81:
  ds_read_b32 v5, v3 offset:0
  s_waitcnt lgkmcnt(0)
  v_readfirstlane_b32 s31, v5
  s_sub_u32 s30, s30, 1
  s_cbranch_scc1 L_end
  s_cmp_lt_i32 s31, 35
  s_cbranch_scc1 L_psp_81
L_pok_80:
  ds_read_b64_tr_b16 v[72:73], v12 offset:0
  ds_read_b64_tr_b16 v[74:75], v12 offset:512
  ds_read_b64_tr_b16 v[76:77], v12 offset:4096
  ds_read_b64_tr_b16 v[78:79], v12 offset:4608
  ds_read_b64_tr_b16 v[80:81], v12 offset:8192
  ds_read_b64_tr_b16 v[82:83], v12 offset:8704
  ds_read_b64_tr_b16 v[84:85], v12 offset:12288
  ds_read_b64_tr_b16 v[86:87], v12 offset:12800
  s_waitcnt lgkmcnt(6)
  v_mfma_f32_16x16x32_bf16 v[104:107], v[72:75], v[68:71], v[104:107]
  s_waitcnt lgkmcnt(4)
  v_mfma_f32_16x16x32_bf16 v[104:107], v[76:79], v[120:123], v[104:107]
  s_waitcnt lgkmcnt(2)
  v_mfma_f32_16x16x32_bf16 v[104:107], v[80:83], v[124:127], v[104:107]
  s_waitcnt lgkmcnt(0)
  v_mfma_f32_16x16x32_bf16 v[104:107], v[84:87], v[128:131], v[104:107]
  s_cmp_ge_i32 s31, 38
  s_cbranch_scc1 L_pok_82
L_psp_83:
  ds_read_b32 v5, v3 offset:0
  s_waitcnt lgkmcnt(0)
  v_readfirstlane_b32 s31, v5
  s_sub_u32 s30, s30, 1
  s_cbranch_scc1 L_end
  s_cmp_lt_i32 s31, 38
  s_cbranch_scc1 L_psp_83
L_pok_82:
  ds_read_b64_tr_b16 v[88:89], v12 offset:16384
  ds_read_b64_tr_b16 v[90:91], v12 offset:16896
  ds_read_b64_tr_b16 v[92:93], v12 offset:20480
  ds_read_b64_tr_b16 v[94:95], v12 offset:20992
  ds_read_b64_tr_b16 v[96:97], v12 offset:24576
  ds_read_b64_tr_b16 v[98:99], v12 offset:25088
  s_waitcnt lgkmcnt(4)
  v_mfma_f32_16x16x32_bf16 v[104:107], v[88:91], v[132:135], v[104:107]
  s_waitcnt lgkmcnt(2)
  v_mfma_f32_16x16x32_bf16 v[104:107], v[92:95], v[144:147], v[104:107]
  s_waitcnt lgkmcnt(0)
  v_mfma_f32_16x16x32_bf16 v[104:107], v[96:99], v[148:151], v[104:107]
  s_nop 7
  v_and_or_b32 v112, v104, v4, s50
  v_and_or_b32 v113, v105, v4, s51
  v_and_or_b32 v114, v106, v4, s52
  v_and_or_b32 v115, v107, v4, s53
  s_mov_b64 exec, s[72:73]
  buffer_store_dwordx4 v[112:115], v13, s[36:39], 0 offen sc1
  s_mov_b64 exec, -1
  s_waitcnt vmcnt(1)
  v_cmp_ne_u32 s[98:99], s71, v137
  v_mov_b32 v116, 0
  v_mov_b32 v117, 0
  v_mov_b32 v118, 0
  v_mov_b32 v119, 0
  v_mov_b32 v120, 0
  v_mov_b32 v121, 0
  v_mov_b32 v122, 0
  v_mov_b32 v123, 0
L_gsp_85:
  ds_read_b32 v5, v3 offset:0
  ds_read_b32 v8, v3 offset:296
  s_waitcnt lgkmcnt(0)
  v_readfirstlane_b32 s31, v5
  v_readfirstlane_b32 s59, v8
  s_sub_u32 s30, s30, 1
  s_cbranch_scc1 L_end
  s_cmp_ge_i32 s31, 49
  s_cbranch_scc1 L_gok_84
  s_cmp_lt_u32 s59, 2
  s_cbranch_scc1 L_gsp_85
  s_add_u32 s59, s31, 2
  s_min_i32 s59, s59, 49
  s_cmp_ge_i32 s31, s59
  s_cbranch_scc1 L_pok_86
L_psp_87:
  ds_read_b32 v5, v3 offset:0
  s_waitcnt lgkmcnt(0)
  v_readfirstlane_b32 s31, v5
  s_sub_u32 s30, s30, 1
  s_cbranch_scc1 L_end
  s_cmp_lt_i32 s31, s59
  s_cbranch_scc1 L_psp_87
L_pok_86:
L_gok_84:
  s_mov_b64 exec, s[78:79]
  buffer_load_dwordx4 v[116:119], v14, s[36:39], 0 offen sc1
  s_mov_b64 exec, s[88:89]
  buffer_load_dwordx4 v[120:123], v18, s[36:39], 0 offen sc1
  s_mov_b64 exec, -1
L_csp_90:
  ds_read_b32 v5, v3 offset:4
  s_waitcnt lgkmcnt(0)
  v_readfirstlane_b32 s55, v5
  s_sub_u32 s30, s30, 1
  s_cbranch_scc1 L_end
  s_cmp_lt_u32 s55, 45
  s_cbranch_scc1 L_csp_90
  ds_read_b64_tr_b16 v[72:73], v140 offset:0
  ds_read_b64_tr_b16 v[74:75], v140 offset:1024
  ds_read_b64_tr_b16 v[88:89], v141 offset:0
  ds_read_b64_tr_b16 v[90:91], v141 offset:1024
  ds_read_b64_tr_b16 v[76:77], v140 offset:8192
  ds_read_b64_tr_b16 v[78:79], v140 offset:9216
  ds_read_b64_tr_b16 v[92:93], v141 offset:8192
  ds_read_b64_tr_b16 v[94:95], v141 offset:9216
  ds_read_b64_tr_b16 v[80:81], v140 offset:16384
  ds_read_b64_tr_b16 v[82:83], v140 offset:17408
  ds_read_b64_tr_b16 v[96:97], v141 offset:16384
  ds_read_b64_tr_b16 v[98:99], v141 offset:17408
  ds_read_b64_tr_b16 v[84:85], v140 offset:24576
  ds_read_b64_tr_b16 v[86:87], v140 offset:25600
  ds_read_b64_tr_b16 v[100:101], v141 offset:24576
  ds_read_b64_tr_b16 v[102:103], v141 offset:25600
  s_mov_b64 exec, s[78:79]
  s_waitcnt vmcnt(1)
  v_xor_b32 v116, s50, v116
  v_xor_b32 v117, s51, v117
  v_xor_b32 v118, s52, v118
  v_xor_b32 v119, s53, v119
  v_or3_b32 v5, v116, v117, v118
  v_or_b32 v5, v5, v119
  v_and_b32 v5, 4095, v5
  v_cmp_ne_u32 s[80:81], 0, v5
  s_mov_b64 exec, s[88:89]
  s_waitcnt vmcnt(0)
  v_xor_b32 v120, s50, v120
  v_xor_b32 v121, s51, v121
  v_xor_b32 v122, s52, v122
  v_xor_b32 v123, s53, v123
  v_or3_b32 v5, v120, v121, v122
  v_or_b32 v5, v5, v123
  v_and_b32 v5, 4095, v5
  v_cmp_ne_u32 s[82:83], 0, v5
  s_or_b64 vcc, s[80:81], s[82:83]
  s_cbranch_vccz L_gd_89
L_g_88:
  s_mov_b64 exec, s[80:81]
  buffer_load_dwordx4 v[116:119], v14, s[36:39], 0 offen sc1
  s_mov_b64 exec, s[82:83]
  buffer_load_dwordx4 v[120:123], v18, s[36:39], 0 offen sc1
  s_mov_b64 exec, s[80:81]
  s_waitcnt vmcnt(1)
  v_xor_b32 v116, s50, v116
  v_xor_b32 v117, s51, v117
  v_xor_b32 v118, s52, v118
  v_xor_b32 v119, s53, v119
  v_or3_b32 v5, v116, v117, v118
  v_or_b32 v5, v5, v119
  v_and_b32 v5, 4095, v5
  v_cmp_ne_u32 s[80:81], 0, v5
  s_mov_b64 exec, s[82:83]
  s_waitcnt vmcnt(0)
  v_xor_b32 v120, s50, v120
  v_xor_b32 v121, s51, v121
  v_xor_b32 v122, s52, v122
  v_xor_b32 v123, s53, v123
  v_or3_b32 v5, v120, v121, v122
  v_or_b32 v5, v5, v123
  v_and_b32 v5, 4095, v5
  v_cmp_ne_u32 s[82:83], 0, v5
  s_or_b64 vcc, s[80:81], s[82:83]
  s_sub_u32 s30, s30, 16
  s_cbranch_scc1 L_end
  s_cbranch_vccnz L_g_88
L_gd_89:
  s_mov_b64 exec, -1
  v_permlane16_swap_b32 v116, v118
  v_permlane16_swap_b32 v117, v119
  v_permlane16_swap_b32 v120, v122
  v_permlane16_swap_b32 v121, v123
  v_add_f32 v116, v116, v118
  v_add_f32 v117, v117, v119
  v_add_f32 v120, v120, v122
  v_add_f32 v121, v121, v123
  v_add_f32_dpp v116, v116, v116 row_ror:8 row_mask:0xf bank_mask:0xf
  v_add_f32_dpp v117, v117, v117 row_ror:8 row_mask:0xf bank_mask:0xf
  v_add_f32_dpp v120, v120, v120 row_ror:8 row_mask:0xf bank_mask:0xf
  v_add_f32_dpp v121, v121, v121 row_ror:8 row_mask:0xf bank_mask:0xf
  v_cndmask_b32 v116, v116, v117, s[64:65]
  v_cndmask_b32 v120, v120, v121, s[64:65]
  s_nop 1
  v_permlane32_swap_b32 v116, v120
  v_cvt_pk_bf16_f32 v5, v116, v120
  v_lshlrev_b32 v6, 16, v5
  v_and_b32 v7, 0xffff0000, v5
  v_mul_f32 v8, v6, v6
  v_mov_b32 v9, 0xc0135761
  v_fmac_f32 v9, 0xbdd2d3e8, v8
  v_mul_f32 v9, v9, v6
  v_exp_f32 v9, v9
  s_nop 0
  v_add_f32 v9, 1.0, v9
  v_rcp_f32 v9, v9
  s_nop 0
  v_mul_f32 v9, v9, v6
  v_cvt_pk_bf16_f32 v9, v9, v9
  v_lshlrev_b32 v9, 16, v9
  v_mul_f32 v9, v9, v7
  v_cvt_pk_bf16_f32 v9, v9, v9
  ds_write_b16 v16, v9 offset:1024
  s_mov_b64 exec, 1
  ds_add_u32 v3, v33 offset:268
  s_mov_b64 exec, -1
L_csp_107:
  ds_read_b32 v5, v3 offset:268
  ds_read_b128 v[40:43], v153 offset:0
  ds_read_b128 v[44:47], v153 offset:64
  ds_read_b128 v[48:51], v153 offset:128
  ds_read_b128 v[52:55], v153 offset:192
  ds_read_b32 v158, v155 offset:6788
  s_waitcnt lgkmcnt(0)
  v_readfirstlane_b32 s55, v5
  s_sub_u32 s30, s30, 1
  s_cbranch_scc1 L_end
  s_cmp_lt_u32 s55, 6
  s_cbranch_scc1 L_csp_107
  v_mfma_f32_16x16x32_bf16 v[104:107], v[72:75], v[40:43], 0
  v_mfma_f32_16x16x32_bf16 v[108:111], v[88:91], v[40:43], 0
  v_mfma_f32_16x16x32_bf16 v[104:107], v[76:79], v[44:47], v[104:107]
  v_mfma_f32_16x16x32_bf16 v[108:111], v[92:95], v[44:47], v[108:111]
  v_mfma_f32_16x16x32_bf16 v[104:107], v[80:83], v[48:51], v[104:107]
  v_mfma_f32_16x16x32_bf16 v[108:111], v[96:99], v[48:51], v[108:111]
  v_mfma_f32_16x16x32_bf16 v[104:107], v[84:87], v[52:55], v[104:107]
  v_mfma_f32_16x16x32_bf16 v[108:111], v[100:103], v[52:55], v[108:111]
L_comb:
  s_nop 7
  v_cndmask_b32 v104, v104, v108, s[66:67]
  v_cndmask_b32 v105, v105, v109, s[66:67]
  v_cndmask_b32 v106, v106, v110, s[66:67]
  v_cndmask_b32 v107, v107, v111, s[66:67]
  v_mul_f32 v104, v158, v104
  v_mul_f32 v105, v158, v105
  v_mul_f32 v106, v158, v106
  v_mul_f32 v107, v158, v107
  s_mov_b64 exec, s[62:63]
  ds_write_b128 v154, v[104:107]
  s_mov_b64 exec, 1
  ds_add_rtn_u32 v5, v3, v33 offset:284
  s_mov_b64 exec, -1
  ds_read_b128 v[112:115], v156 offset:8192
  ds_read_b128 v[116:119], v156 offset:9216
  s_waitcnt lgkmcnt(2)
  v_readfirstlane_b32 s55, v5
  s_cmp_lg_u32 s55, 7
  s_cbranch_scc1 L_nlast
  s_waitcnt lgkmcnt(0)
  v_pk_add_f32 v[112:113], v[112:113], v[116:117]
  v_pk_add_f32 v[114:115], v[114:115], v[118:119]
  v_and_or_b32 v112, v112, v4, s50
  v_and_or_b32 v113, v113, v4, s51
  v_and_or_b32 v114, v114, v4, s52
  v_and_or_b32 v115, v115, v4, s53
  s_cmp_lg_u64 s[98:99], 0
  s_cbranch_scc1 L_pw_108
  buffer_store_dwordx4 v[112:115], v157, s[36:39], 0 offen
  s_branch L_pd_109
L_pw_108:
  buffer_store_dwordx4 v[112:115], v157, s[36:39], 0 offen sc1
L_pd_109:
  s_mov_b64 exec, -1
L_nlast:
  s_and_b32 s55, s68, 3
  s_sub_u32 s56, s3, 5
  s_or_b32 s55, s55, s56
  s_cbranch_scc1 L_fin
  buffer_load_dwordx4 v[40:43], v22, s[36:39], 0 offen nt
  buffer_load_dwordx4 v[44:47], v22, s[36:39], 0 offen offset:1024 nt
  buffer_load_dwordx4 v[48:51], v22, s[36:39], 0 offen offset:2048 nt
  buffer_load_dwordx4 v[52:55], v22, s[36:39], 0 offen offset:3072 nt
  s_waitcnt vmcnt(3)
  v_xor_b32 v40, s50, v40
  v_xor_b32 v41, s51, v41
  v_xor_b32 v42, s52, v42
  v_xor_b32 v43, s53, v43
  v_or3_b32 v5, v40, v41, v42
  v_or_b32 v5, v5, v43
  v_and_b32 v5, 4095, v5
  v_cmp_ne_u32 s[80:81], 0, v5
  s_waitcnt vmcnt(2)
  v_xor_b32 v44, s50, v44
  v_xor_b32 v45, s51, v45
  v_xor_b32 v46, s52, v46
  v_xor_b32 v47, s53, v47
  v_or3_b32 v5, v44, v45, v46
  v_or_b32 v5, v5, v47
  v_and_b32 v5, 4095, v5
  v_cmp_ne_u32 s[82:83], 0, v5
  s_waitcnt vmcnt(1)
  v_xor_b32 v48, s50, v48
  v_xor_b32 v49, s51, v49
  v_xor_b32 v50, s52, v50
  v_xor_b32 v51, s53, v51
  v_or3_b32 v5, v48, v49, v50
  v_or_b32 v5, v5, v51
  v_and_b32 v5, 4095, v5
  v_cmp_ne_u32 s[84:85], 0, v5
  s_waitcnt vmcnt(0)
  v_xor_b32 v52, s50, v52
  v_xor_b32 v53, s51, v53
  v_xor_b32 v54, s52, v54
  v_xor_b32 v55, s53, v55
  v_or3_b32 v5, v52, v53, v54
  v_or_b32 v5, v5, v55
  v_and_b32 v5, 4095, v5
  v_cmp_ne_u32 s[86:87], 0, v5
  s_or_b64 vcc, s[80:81], s[82:83]
  s_or_b64 vcc, vcc, s[84:85]
  s_or_b64 vcc, vcc, s[86:87]
  s_cbranch_vccz L_gd_111
L_g_110:
  s_cmp_lg_u64 s[98:99], 0
  s_cbranch_scc1 L_ra_112
  s_mov_b64 exec, s[80:81]
  buffer_load_dwordx4 v[40:43], v22, s[36:39], 0 offen nt
  s_mov_b64 exec, s[82:83]
  buffer_load_dwordx4 v[44:47], v22, s[36:39], 0 offen offset:1024 nt
  s_mov_b64 exec, s[84:85]
  buffer_load_dwordx4 v[48:51], v22, s[36:39], 0 offen offset:2048 nt
  s_mov_b64 exec, s[86:87]
  buffer_load_dwordx4 v[52:55], v22, s[36:39], 0 offen offset:3072 nt
  s_branch L_rb_113
L_ra_112:
  s_mov_b64 exec, s[80:81]
  buffer_load_dwordx4 v[40:43], v22, s[36:39], 0 offen sc1
  s_mov_b64 exec, s[82:83]
  buffer_load_dwordx4 v[44:47], v22, s[36:39], 0 offen offset:1024 sc1
  s_mov_b64 exec, s[84:85]
  buffer_load_dwordx4 v[48:51], v22, s[36:39], 0 offen offset:2048 sc1
  s_mov_b64 exec, s[86:87]
  buffer_load_dwordx4 v[52:55], v22, s[36:39], 0 offen offset:3072 sc1
L_rb_113:
  s_mov_b64 exec, s[80:81]
  s_waitcnt vmcnt(3)
  v_xor_b32 v40, s50, v40
  v_xor_b32 v41, s51, v41
  v_xor_b32 v42, s52, v42
  v_xor_b32 v43, s53, v43
  v_or3_b32 v5, v40, v41, v42
  v_or_b32 v5, v5, v43
  v_and_b32 v5, 4095, v5
  v_cmp_ne_u32 s[80:81], 0, v5
  s_mov_b64 exec, s[82:83]
  s_waitcnt vmcnt(2)
  v_xor_b32 v44, s50, v44
  v_xor_b32 v45, s51, v45
  v_xor_b32 v46, s52, v46
  v_xor_b32 v47, s53, v47
  v_or3_b32 v5, v44, v45, v46
  v_or_b32 v5, v5, v47
  v_and_b32 v5, 4095, v5
  v_cmp_ne_u32 s[82:83], 0, v5
  s_mov_b64 exec, s[84:85]
  s_waitcnt vmcnt(1)
  v_xor_b32 v48, s50, v48
  v_xor_b32 v49, s51, v49
  v_xor_b32 v50, s52, v50
  v_xor_b32 v51, s53, v51
  v_or3_b32 v5, v48, v49, v50
  v_or_b32 v5, v5, v51
  v_and_b32 v5, 4095, v5
  v_cmp_ne_u32 s[84:85], 0, v5
  s_mov_b64 exec, s[86:87]
  s_waitcnt vmcnt(0)
  v_xor_b32 v52, s50, v52
  v_xor_b32 v53, s51, v53
  v_xor_b32 v54, s52, v54
  v_xor_b32 v55, s53, v55
  v_or3_b32 v5, v52, v53, v54
  v_or_b32 v5, v5, v55
  v_and_b32 v5, 4095, v5
  v_cmp_ne_u32 s[86:87], 0, v5
  s_or_b64 vcc, s[80:81], s[82:83]
  s_or_b64 vcc, vcc, s[84:85]
  s_or_b64 vcc, vcc, s[86:87]
  s_sub_u32 s30, s30, 16
  s_cbranch_scc1 L_end
  s_cbranch_vccnz L_g_110
L_gd_111:
  s_mov_b64 exec, -1
  v_pk_add_f32 v[40:41], v[40:41], v[44:45]
  v_pk_add_f32 v[42:43], v[42:43], v[46:47]
  v_pk_add_f32 v[48:49], v[48:49], v[52:53]
  v_pk_add_f32 v[50:51], v[50:51], v[54:55]
  v_pk_add_f32 v[40:41], v[40:41], v[48:49]
  v_pk_add_f32 v[42:43], v[42:43], v[50:51]
  s_nop 1
  v_permlane32_swap_b32 v40, v42
  v_permlane32_swap_b32 v41, v43
  v_add_f32 v40, v40, v42
  v_add_f32 v41, v41, v43
  s_nop 1
  v_permlane16_swap_b32 v40, v41
  v_add_f32 v40, v40, v41
  s_nop 1
  v_add_f32_dpp v40, v40, v40 row_ror:8 row_mask:0xf bank_mask:0xf
  s_mov_b32 exec_lo, 0x00ff00ff
  s_mov_b32 exec_hi, 0x00ff00ff
  v_cvt_pk_bf16_f32 v6, v40, v40
  buffer_store_short v6, v23, s[44:47], 0 offen
  s_cmp_lg_u32 s2, 0
  s_cbranch_scc1 L_fin
  s_mov_b64 exec, 1
  v_mov_b32 v6, s48
  v_mov_b32 v7, s49
  s_mov_b32 s55, 192512
  v_mov_b32 v8, s55
  global_store_dwordx2 v8, v[6:7], s[28:29] sc1
L_fin:
  s_mov_b64 exec, -1
L_end:
  s_endpgm
.section .rodata,"a"
.p2align 6
.amdhsa_kernel gated_mix__sliding_block_cached__geglu_ffn__decode_kernel
  .amdhsa_next_free_vgpr 160
  .amdhsa_next_free_sgpr 102
  .amdhsa_accum_offset 160
  .amdhsa_group_segment_fixed_size 0
  .amdhsa_kernarg_size 104
  .amdhsa_user_sgpr_count 2
  .amdhsa_user_sgpr_kernarg_segment_ptr 1
  .amdhsa_system_sgpr_workgroup_id_x 1
.end_amdhsa_kernel
```
